```python
import torch

def _softmax(x, axis=-1):
    return torch.softmax(x, dim=axis)
def _gelu(x):
    return torch.nn.functional.gelu(x, approximate="tanh")
def _silu(x):
    return torch.nn.functional.silu(x)
def _sigmoid(x):
    return torch.sigmoid(x)
def _layernorm(x, axis=-1, eps=1e-5):
    m = x.mean(dim=axis, keepdim=True)
    v = x.var(dim=axis, keepdim=True, unbiased=False)
    return (x - m) / torch.sqrt(v + eps)
def _scatter_add(tgt, idx, src, axis=0):
    return tgt.clone().index_add_(axis, idx, src)
def _segment_sum(src, seg, n):
    out = torch.zeros((n,) + src.shape[1:], dtype=src.dtype)
    return out.index_add_(0, seg, src)
def _pad(x, pw):
    flat = tuple(v for pair in reversed(pw) for v in pair)
    return torch.nn.functional.pad(x, flat)

kernel_name = 'gated_mix__linear_attn_block__mixer_token_mlp__prompt'

def setup_inputs():

    _w = (lambda a: (lambda t: t.to(torch.bfloat16) if t.is_floating_point() else t)(torch.as_tensor(a)))
    def _A_setup():
        B, S, D = 1, 2048, 512
        return {
            "x": _w((lambda *s: torch.randn(*s, dtype=torch.bfloat16) * 0.05)(B, S, D)),
            "wqkv": _w((lambda *s: torch.randn(*s, dtype=torch.bfloat16) * 0.4)(D, 3 * D)),
            "wo": _w((lambda *s: torch.randn(*s, dtype=torch.bfloat16) * 0.05)(D, D)),
        }
    _A_in = _A_setup()

    def _B_setup():
        B, S, D, F = 1, 2048, 512, 1376
        return {
            "x": _w((lambda *s: torch.randn(*s, dtype=torch.bfloat16) * 0.05)(B, S, D)),
            "w1": _w((lambda *s: torch.randn(*s, dtype=torch.bfloat16) * 0.4)(S, F) * (S ** -0.5)),
            "b1": _w((lambda *s: torch.randn(*s, dtype=torch.bfloat16) * 3.2)(F) * 0.02),
            "w2": _w((lambda *s: torch.randn(*s, dtype=torch.bfloat16) * 0.05)(F, S) * (F ** -0.5)),
            "b2": _w((lambda *s: torch.randn(*s, dtype=torch.bfloat16) * 0.1)(S) * 0.02),
        }
    _B_in = _B_setup()

    return {
        "A_x": _A_in["x"],
        "A_wqkv": _A_in["wqkv"],
        "A_wo": _A_in["wo"],
        "B_x": _B_in["x"],
        "B_w1": _B_in["w1"],
        "B_b1": _B_in["b1"],
        "B_w2": _B_in["w2"],
        "B_b2": _B_in["b2"],
        "gate_w": _w((lambda *s: torch.randn(*s, dtype=torch.bfloat16) * 0.05)(512) * 16.0),
    }

def reference(A_x, A_wqkv, A_wo, B_x, B_w1, B_b1, B_w2, B_b2, gate_w):
    def _A_ref(x, wqkv, wo):
        B, S, D = x.shape
        H = 32; Dh = D // H
        qkv = (lambda x, *d: x.permute(*d))((x @ wqkv).reshape(B, S, 3, H, Dh), 2, 0, 3, 1, 4)
        q, k, v = qkv[0], qkv[1], qkv[2]
        phi = lambda t: torch.where(t > 0, t + 1, torch.exp(t)) + 1e-6
        pq, pk = phi(q), phi(k)
        kv = torch.einsum("bhsd,bhse->bhde", pk, v)
        z = torch.einsum("bhsd->bhd", pk)
        num = torch.einsum("bhqd,bhde->bhqe", pq, kv)
        den = torch.einsum("bhqd,bhd->bhq", pq, z)[..., None] + 1e-6
        o = num / den
        return (lambda x, *d: x.permute(*d))(o, 0, 2, 1, 3).reshape(B, S, D) @ wo

    def _B_ref(x, w1, b1, w2, b2):
        B, S, D = x.shape
        h = _layernorm(x, axis=-1)
        u = torch.einsum("bsd,sf->bdf", h, w1) + b1
        u = _gelu(u)
        y = torch.einsum("bdf,fs->bds", u, w2) + b2
        return (lambda x, *d: x.permute(*d))(y, 0, 2, 1)

    x = A_x
    g = _sigmoid((x * gate_w).sum(-1, keepdims=True))
    a = _A_ref(x, A_wqkv, A_wo)
    b = _B_ref(x, B_w1, B_b1, B_w2, B_b2)
    return g * a + (1 - g) * b
```

```asm
; @launch grid=(256,1,1) block=(256,1,1) lds=163840
.amdgcn_target "amdgcn-amd-amdhsa--gfx950"
.set CODE_LAST, 37072
.set CODEPF_LINES, 3
.text
.globl gated_mix__linear_attn_block__mixer_token_mlp__prompt_kernel
.p2align 8
.type gated_mix__linear_attn_block__mixer_token_mlp__prompt_kernel,@function
gated_mix__linear_attn_block__mixer_token_mlp__prompt_kernel:
L_start:
    s_cmp_ge_u32 s2, 256
    s_cbranch_scc1 L_end
    s_load_dwordx16 s[16:31], s[0:1], 0
    s_load_dwordx8 s[32:39], s[0:1], 64
    v_lshrrev_b32 v2, 6, v0
    v_and_b32 v1, 63, v0
    v_readfirstlane_b32 s3, v2
    s_and_b32 s4, s2, 7
    s_lshr_b32 s5, s2, 3
    s_lshl_b32 s64, s3, 11
    s_getpc_b64 s[14:15]
L_pc1:
    s_sub_u32 s14, s14, L_pc1-L_start
    s_subb_u32 s15, s15, 0
    s_lshl_b32 s12, s5, 2
    s_add_u32 s12, s12, s3
    s_mul_i32 s12, s12, CODEPF_LINES*128
    v_min_u32 v7, CODEPF_LINES-1, v1
    v_lshlrev_b32 v7, 7, v7
    v_add_u32 v7, s12, v7
    v_min_u32 v7, CODE_LAST, v7
    global_load_dword v255, v7, s[14:15]
    s_cmp_lt_u32 s5, 16
    s_cbranch_scc0 L_nota
    s_lshr_b32 s7, s4, 1
    s_lshl_b32 s7, s7, 2
    s_and_b32 s12, s5, 3
    s_add_u32 s7, s7, s12
    s_and_b32 s13, s4, 1
    s_lshr_b32 s14, s5, 2
    s_lshl_b32 s70, s13, 2
    s_add_u32 s70, s70, s14
    s_lshl_b32 s8, s70, 7
    s_add_u32 s9, s8, 2048
    s_add_u32 s8, s8, 1024
    s_add_u32 s69, s12, s14
    s_lshl_b32 s69, s69, 1
    s_lshl_b32 s12, s7, 7
    s_lshl_b32 s13, s3, 5
    s_add_u32 s12, s12, s13
    v_lshrrev_b32 v8, 3, v1
    v_add_u32 v8, s12, v8
    v_lshlrev_b32 v8, 10, v8
    v_lshrrev_b32 v6, 4, v1
    v_xor_b32 v6, v6, v1
    v_and_b32 v6, 7, v6
    v_xor_b32 v7, 4, v6
    v_lshl_add_u32 v9, v7, 4, v8
    v_add_u32 v9, 7168, v9
    v_lshl_add_u32 v8, v6, 4, v8
    v_add_u32 v10, 14336, v8
    v_add_u32 v11, 14336, v9
    v_lshrrev_b32 v12, 3, v1
    v_mul_u32_u24 v12, 3072, v12
    v_bfe_u32 v6, v1, 4, 1
    v_lshlrev_b32 v6, 2, v6
    v_xor_b32 v6, v6, v1
    v_and_b32 v6, 7, v6
    v_lshl_add_u32 v12, v6, 4, v12
    v_add_u32 v13, 23552, v12
    s_mul_i32 s12, s3, 49152
    s_add_u32 s8, s8, s12
    s_add_u32 s9, s9, s12
    s_waitcnt lgkmcnt(0)
    s_add_u32 s14, s38, 11723776
    s_addc_u32 s15, s39, 0
    s_load_dword s96, s[14:15], 0
    s_mov_b32 s48, s16
    s_mov_b32 s49, s17
    s_mov_b32 s50, 2097152
    s_mov_b32 s51, 0x20000
    s_mov_b32 s52, s18
    s_mov_b32 s53, s19
    s_mov_b32 s54, 1572864
    s_mov_b32 s55, 0x20000
    v_and_b32 v6, 31, v1
    s_and_b32 s12, s3, 1
    s_lshl_b32 s12, s12, 6
    v_add_u32 v6, s12, v6
    v_bfe_u32 v7, v6, 1, 3
    v_lshrrev_b32 v14, 5, v1
    v_xor_b32 v7, v7, v14
    v_lshlrev_b32 v7, 4, v7
    v_lshl_add_u32 v14, v6, 7, v7
    v_xor_b32 v15, 32, v14
    v_xor_b32 v16, 64, v14
    v_xor_b32 v17, 96, v14
    v_add_u32 v18, 0x10000, v14
    v_add_u32 v19, 0x10000, v15
    v_add_u32 v20, 0x10000, v16
    v_add_u32 v21, 0x10000, v17
    v_lshrrev_b32 v22, 5, v1
    v_lshlrev_b32 v22, 10, v22
    v_bfe_u32 v6, v1, 2, 2
    v_lshl_add_u32 v22, v6, 7, v22
    v_bfe_u32 v6, v1, 3, 1
    v_lshl_add_u32 v22, v6, 6, v22
    v_bfe_u32 v6, v1, 4, 1
    v_lshl_add_u32 v22, v6, 5, v22
    v_and_b32 v6, 3, v1
    v_lshl_add_u32 v22, v6, 3, v22
    s_lshr_b32 s12, s3, 1
    s_lshl_b32 s12, s12, 6
    v_xor_b32 v22, s12, v22
    v_add_u32 v23, 8192, v22
    v_add_u32 v24, 0x10000, v22
    v_add_u32 v25, 0x10000, v23
    s_mov_b32 s40, s38
    s_mov_b32 s41, s39
    s_mov_b32 s42, 33554432
    s_mov_b32 s43, 0x20000
    s_mov_b32 s56, s24
    s_mov_b32 s57, s25
    s_mov_b32 s58, 5636096
    s_mov_b32 s59, 0x20000
    s_lshl_b32 s97, s64, 1
    s_add_u32 m0, s97, 0
    s_add_u32 s98, s69, 0
    s_and_b32 s98, s98, 7
    s_lshl_b32 s97, s98, 7
    s_mul_i32 s98, s98, 196608
    buffer_load_dwordx4 v8, s[48:51], s97 offen offset:0 lds
    buffer_load_dwordx4 v9, s[48:51], s97 offen offset:1024 lds
    buffer_load_dwordx4 v10, s[48:51], s97 offen offset:2048 lds
    buffer_load_dwordx4 v11, s[48:51], s97 offen offset:3072 lds
    s_add_u32 m0, s64, 16384
    s_add_u32 s97, s98, s8
    buffer_load_dwordx4 v12, s[52:55], s97 offen offset:0 lds
    buffer_load_dwordx4 v13, s[52:55], s97 offen offset:1024 lds
    s_add_u32 m0, s64, 24576
    s_add_u32 s97, s98, s9
    buffer_load_dwordx4 v12, s[52:55], s97 offen offset:0 lds
    buffer_load_dwordx4 v13, s[52:55], s97 offen offset:1024 lds
    s_lshl_b32 s97, s64, 1
    s_add_u32 m0, s97, 32768
    s_add_u32 s98, s69, 1
    s_and_b32 s98, s98, 7
    s_lshl_b32 s97, s98, 7
    s_mul_i32 s98, s98, 196608
    buffer_load_dwordx4 v8, s[48:51], s97 offen offset:0 lds
    buffer_load_dwordx4 v9, s[48:51], s97 offen offset:1024 lds
    buffer_load_dwordx4 v10, s[48:51], s97 offen offset:2048 lds
    buffer_load_dwordx4 v11, s[48:51], s97 offen offset:3072 lds
    s_add_u32 m0, s64, 49152
    s_add_u32 s97, s98, s8
    buffer_load_dwordx4 v12, s[52:55], s97 offen offset:0 lds
    buffer_load_dwordx4 v13, s[52:55], s97 offen offset:1024 lds
    s_add_u32 m0, s64, 57344
    s_add_u32 s97, s98, s9
    buffer_load_dwordx4 v12, s[52:55], s97 offen offset:0 lds
    buffer_load_dwordx4 v13, s[52:55], s97 offen offset:1024 lds
    s_branch L_a0
L_nota:
    s_lshl_b32 s68, s4, 4
    s_add_u32 s68, s68, s5
    s_sub_u32 s68, s68, 16
    s_lshl_b32 s68, s68, 1
    s_lshr_b32 s10, s3, 1
    s_add_u32 s68, s68, s10
    s_lshl_b32 s10, s68, 3
    s_and_b32 s11, s3, 1
    s_lshl_b32 s11, s11, 2
    s_add_u32 s10, s10, s11
    v_lshrrev_b32 v3, 5, v1
    v_add_u32 v3, s10, v3
    v_and_b32 v4, 31, v1
    v_lshlrev_b32 v4, 4, v4
    v_lshl_add_u32 v5, v3, 10, v4
    s_waitcnt lgkmcnt(0)
    s_add_u32 s14, s38, 11723776
    s_addc_u32 s15, s39, 0
    s_load_dword s96, s[14:15], 0
    s_mov_b32 s48, s16
    s_mov_b32 s49, s17
    s_mov_b32 s50, 2097152
    s_mov_b32 s51, 0x20000
    s_mov_b32 s60, s32
    s_mov_b32 s61, s33
    s_mov_b32 s62, 1024
    s_mov_b32 s63, 0x20000
    buffer_load_dwordx4 v[176:179], v5, s[48:51], 0 offen offset:0
    buffer_load_dwordx4 v[180:183], v5, s[48:51], 0 offen offset:512
    buffer_load_dwordx4 v[184:187], v5, s[48:51], 0 offen offset:2048
    buffer_load_dwordx4 v[188:191], v5, s[48:51], 0 offen offset:2560
    buffer_load_dwordx4 v[192:195], v4, s[60:63], 0 offen
    buffer_load_dwordx4 v[196:199], v4, s[60:63], 0 offen offset:512
    s_mov_b32 s40, s38
    s_mov_b32 s41, s39
    s_mov_b32 s42, 33554432
    s_mov_b32 s43, 0x20000
    s_mov_b32 s56, s24
    s_mov_b32 s57, s25
    s_mov_b32 s58, 5636096
    s_mov_b32 s59, 0x20000
    s_mov_b32 s52, s20
    s_mov_b32 s53, s21
    s_mov_b32 s54, 524288
    s_mov_b32 s55, 0x20000
    s_lshl_b32 s12, s68, 1
    s_and_b32 s13, s3, 1
    s_add_u32 s12, s12, s13
    s_lshl_b32 s12, s12, 10
    v_min_u32 v7, 7, v1
    v_lshlrev_b32 v7, 7, v7
    buffer_load_dword v63, v7, s[52:55], s12 offen
    v_bfe_u32 v6, v1, 4, 1
    v_mul_u32_u24 v6, 2752, v6
    v_and_b32 v7, 15, v1
    v_lshlrev_b32 v7, 7, v7
    v_min_u32 v7, 1532, v7
    v_add_u32 v6, v6, v7
    s_and_b32 s12, s5, 7
    s_lshl_b32 s12, s12, 6
    s_lshl_b32 s13, s3, 2
    s_add_u32 s12, s12, s13
    s_bfe_u32 s13, s5, 0x10003
    s_lshl_b32 s13, s13, 1
    s_add_u32 s12, s12, s13
    s_lshr_b32 s13, s4, 1
    s_lshl_b32 s13, s13, 9
    s_add_u32 s12, s12, s13
    s_add_u32 s12, s12, 48
    s_mul_i32 s12, s12, 2752
    s_and_b32 s13, s4, 1
    s_mul_i32 s13, s13, 1280
    s_add_u32 s12, s12, s13
    buffer_load_dword v63, v6, s[56:59], s12 offen
    s_mov_b32 s52, s18
    s_mov_b32 s53, s19
    s_mov_b32 s54, 1572864
    s_mov_b32 s55, 0x20000
    s_lshr_b32 s7, s4, 1
    s_lshl_b32 s7, s7, 2
    s_and_b32 s12, s5, 3
    s_add_u32 s7, s7, s12
    s_and_b32 s13, s4, 1
    s_lshr_b32 s14, s5, 2
    s_sub_u32 s14, s14, 2
    s_lshl_b32 s70, s13, 1
    s_add_u32 s70, s70, s14
    s_sub_u32 s70, s70, 4
    s_lshl_b32 s8, s70, 8
    s_add_u32 s9, s8, 128
    s_add_u32 s69, s12, s14
    s_lshl_b32 s69, s69, 1
    s_lshl_b32 s12, s7, 7
    s_lshl_b32 s13, s3, 5
    s_add_u32 s12, s12, s13
    v_lshrrev_b32 v8, 3, v1
    v_add_u32 v8, s12, v8
    v_lshlrev_b32 v8, 10, v8
    v_lshrrev_b32 v6, 4, v1
    v_xor_b32 v6, v6, v1
    v_and_b32 v6, 7, v6
    v_xor_b32 v7, 4, v6
    v_lshl_add_u32 v9, v7, 4, v8
    v_add_u32 v9, 7168, v9
    v_lshl_add_u32 v8, v6, 4, v8
    v_add_u32 v10, 14336, v8
    v_add_u32 v11, 14336, v9
    v_lshrrev_b32 v12, 3, v1
    v_mul_u32_u24 v12, 3072, v12
    v_bfe_u32 v6, v1, 4, 1
    v_lshlrev_b32 v6, 2, v6
    v_xor_b32 v6, v6, v1
    v_and_b32 v6, 7, v6
    v_lshl_add_u32 v12, v6, 4, v12
    v_add_u32 v13, 23552, v12
    s_mul_i32 s12, s3, 49152
    s_add_u32 s8, s8, s12
    s_add_u32 s9, s9, s12
    v_mov_b32 v62, 0x3f803f80
    v_mov_b32 v64, 0
    v_mov_b32 v65, 0
    v_mov_b32 v66, 0
    v_mov_b32 v68, 0
    v_mov_b32 v69, 0
    v_mov_b32 v70, 0
    s_mul_i32 s12, s3, 4352
    s_add_u32 s12, s12, 98304
    v_lshrrev_b32 v6, 5, v1
    v_mul_u32_u24 v6, 1088, v6
    v_add_u32 v6, v6, v4
    v_add_u32 v6, s12, v6
    v_bfe_u32 v5, v1, 2, 2
    v_mul_u32_u24 v5, 1088, v5
    s_lshr_b32 s12, s3, 1
    s_mul_i32 s12, s12, 8704
    s_and_b32 s13, s3, 1
    s_lshl_b32 s14, s13, 9
    s_add_u32 s12, s12, s14
    s_add_u32 s12, s12, 98304
    v_lshrrev_b32 v7, 4, v1
    v_lshl_add_u32 v5, v7, 5, v5
    v_and_b32 v7, 3, v1
    v_lshl_add_u32 v5, v7, 3, v5
    v_add_u32 v5, s12, v5
    s_lshl_b32 s37, s13, 8
    s_add_u32 s37, s37, s68
    s_lshl_b32 s37, s37, 6
    s_add_u32 s37, s37, 11534336
    s_lshl_b32 s68, s68, 13
    s_lshl_b32 s13, s13, 12
    s_add_u32 s68, s68, s13
    s_waitcnt vmcnt(2)
    v_dot2c_f32_bf16 v64, v176, v62
    v_dot2c_f32_bf16 v65, v176, v176
    v_dot2c_f32_bf16 v66, v176, v192
    v_dot2c_f32_bf16 v64, v177, v62
    v_dot2c_f32_bf16 v65, v177, v177
    v_dot2c_f32_bf16 v66, v177, v193
    v_dot2c_f32_bf16 v64, v178, v62
    v_dot2c_f32_bf16 v65, v178, v178
    v_dot2c_f32_bf16 v66, v178, v194
    v_dot2c_f32_bf16 v64, v179, v62
    v_dot2c_f32_bf16 v65, v179, v179
    v_dot2c_f32_bf16 v66, v179, v195
    v_dot2c_f32_bf16 v64, v180, v62
    v_dot2c_f32_bf16 v65, v180, v180
    v_dot2c_f32_bf16 v66, v180, v196
    v_dot2c_f32_bf16 v64, v181, v62
    v_dot2c_f32_bf16 v65, v181, v181
    v_dot2c_f32_bf16 v66, v181, v197
    v_dot2c_f32_bf16 v64, v182, v62
    v_dot2c_f32_bf16 v65, v182, v182
    v_dot2c_f32_bf16 v66, v182, v198
    v_dot2c_f32_bf16 v64, v183, v62
    v_dot2c_f32_bf16 v65, v183, v183
    v_dot2c_f32_bf16 v66, v183, v199
    v_dot2c_f32_bf16 v68, v184, v62
    v_dot2c_f32_bf16 v69, v184, v184
    v_dot2c_f32_bf16 v70, v184, v192
    v_dot2c_f32_bf16 v68, v185, v62
    v_dot2c_f32_bf16 v69, v185, v185
    v_dot2c_f32_bf16 v70, v185, v193
    v_dot2c_f32_bf16 v68, v186, v62
    v_dot2c_f32_bf16 v69, v186, v186
    v_dot2c_f32_bf16 v70, v186, v194
    v_dot2c_f32_bf16 v68, v187, v62
    v_dot2c_f32_bf16 v69, v187, v187
    v_dot2c_f32_bf16 v70, v187, v195
    v_dot2c_f32_bf16 v68, v188, v62
    v_dot2c_f32_bf16 v69, v188, v188
    v_dot2c_f32_bf16 v70, v188, v196
    v_dot2c_f32_bf16 v68, v189, v62
    v_dot2c_f32_bf16 v69, v189, v189
    v_dot2c_f32_bf16 v70, v189, v197
    v_dot2c_f32_bf16 v68, v190, v62
    v_dot2c_f32_bf16 v69, v190, v190
    v_dot2c_f32_bf16 v70, v190, v198
    v_dot2c_f32_bf16 v68, v191, v62
    v_dot2c_f32_bf16 v69, v191, v191
    v_dot2c_f32_bf16 v70, v191, v199
    s_nop 0
    v_add_f32_dpp v64, v64, v64 quad_perm:[1,0,3,2] row_mask:0xf bank_mask:0xf
    v_add_f32_dpp v65, v65, v65 quad_perm:[1,0,3,2] row_mask:0xf bank_mask:0xf
    v_add_f32_dpp v66, v66, v66 quad_perm:[1,0,3,2] row_mask:0xf bank_mask:0xf
    v_add_f32_dpp v68, v68, v68 quad_perm:[1,0,3,2] row_mask:0xf bank_mask:0xf
    v_add_f32_dpp v69, v69, v69 quad_perm:[1,0,3,2] row_mask:0xf bank_mask:0xf
    v_add_f32_dpp v70, v70, v70 quad_perm:[1,0,3,2] row_mask:0xf bank_mask:0xf
    v_add_f32_dpp v64, v64, v64 quad_perm:[2,3,0,1] row_mask:0xf bank_mask:0xf
    v_add_f32_dpp v65, v65, v65 quad_perm:[2,3,0,1] row_mask:0xf bank_mask:0xf
    v_add_f32_dpp v66, v66, v66 quad_perm:[2,3,0,1] row_mask:0xf bank_mask:0xf
    v_add_f32_dpp v68, v68, v68 quad_perm:[2,3,0,1] row_mask:0xf bank_mask:0xf
    v_add_f32_dpp v69, v69, v69 quad_perm:[2,3,0,1] row_mask:0xf bank_mask:0xf
    v_add_f32_dpp v70, v70, v70 quad_perm:[2,3,0,1] row_mask:0xf bank_mask:0xf
    v_add_f32_dpp v64, v64, v64 row_half_mirror row_mask:0xf bank_mask:0xf
    v_add_f32_dpp v65, v65, v65 row_half_mirror row_mask:0xf bank_mask:0xf
    v_add_f32_dpp v66, v66, v66 row_half_mirror row_mask:0xf bank_mask:0xf
    v_add_f32_dpp v68, v68, v68 row_half_mirror row_mask:0xf bank_mask:0xf
    v_add_f32_dpp v69, v69, v69 row_half_mirror row_mask:0xf bank_mask:0xf
    v_add_f32_dpp v70, v70, v70 row_half_mirror row_mask:0xf bank_mask:0xf
    v_add_f32_dpp v64, v64, v64 row_mirror row_mask:0xf bank_mask:0xf
    v_add_f32_dpp v65, v65, v65 row_mirror row_mask:0xf bank_mask:0xf
    v_add_f32_dpp v66, v66, v66 row_mirror row_mask:0xf bank_mask:0xf
    v_add_f32_dpp v68, v68, v68 row_mirror row_mask:0xf bank_mask:0xf
    v_add_f32_dpp v69, v69, v69 row_mirror row_mask:0xf bank_mask:0xf
    v_add_f32_dpp v70, v70, v70 row_mirror row_mask:0xf bank_mask:0xf
    v_mov_b32 v80, v64
    v_mov_b32 v81, v65
    v_mov_b32 v82, v66
    v_mov_b32 v84, v68
    v_mov_b32 v85, v69
    v_mov_b32 v86, v70
    v_permlane16_swap_b32 v80, v64
    v_permlane16_swap_b32 v81, v65
    v_permlane16_swap_b32 v82, v66
    v_permlane16_swap_b32 v84, v68
    v_permlane16_swap_b32 v85, v69
    v_permlane16_swap_b32 v86, v70
    v_add_f32 v64, v64, v80
    v_add_f32 v65, v65, v81
    v_add_f32 v66, v66, v82
    v_add_f32 v68, v68, v84
    v_add_f32 v69, v69, v85
    v_add_f32 v70, v70, v86
    v_mul_f32 v64, 0x3b000000, v64
    v_mul_f32 v65, 0x3b000000, v65
    v_mul_f32 v66, 0x3fb8aa3b, v66
    v_mul_f32 v68, 0x3b000000, v68
    v_mul_f32 v69, 0x3b000000, v69
    v_mul_f32 v70, 0x3fb8aa3b, v70
    v_fma_f32 v65, -v64, v64, v65
    v_min_f32 v66, 0x42680000, v66
    v_fma_f32 v69, -v68, v68, v69
    v_min_f32 v70, 0x42680000, v70
    v_max_f32 v65, 0, v65
    v_max_f32 v69, 0, v69
    v_add_f32 v65, 0x3727c5ac, v65
    v_add_f32 v69, 0x3727c5ac, v69
    v_rsq_f32 v80, v65
    v_exp_f32 v66, v66
    v_rsq_f32 v84, v69
    v_exp_f32 v70, v70
    v_lshlrev_b32 v200, 16, v176
    v_and_b32 v201, 0xffff0000, v176
    v_lshlrev_b32 v202, 16, v177
    v_and_b32 v203, 0xffff0000, v177
    v_lshlrev_b32 v204, 16, v178
    v_and_b32 v205, 0xffff0000, v178
    v_lshlrev_b32 v206, 16, v179
    v_and_b32 v207, 0xffff0000, v179
    v_lshlrev_b32 v208, 16, v180
    v_and_b32 v209, 0xffff0000, v180
    v_lshlrev_b32 v210, 16, v181
    v_and_b32 v211, 0xffff0000, v181
    v_lshlrev_b32 v212, 16, v182
    v_and_b32 v213, 0xffff0000, v182
    v_lshlrev_b32 v214, 16, v183
    v_and_b32 v215, 0xffff0000, v183
    v_mul_f32 v82, -v64, v80
    v_pk_fma_f32 v[200:201], v[200:201], v[80:81], v[82:83] op_sel_hi:[1,0,0]
    v_pk_fma_f32 v[202:203], v[202:203], v[80:81], v[82:83] op_sel_hi:[1,0,0]
    v_pk_fma_f32 v[204:205], v[204:205], v[80:81], v[82:83] op_sel_hi:[1,0,0]
    v_pk_fma_f32 v[206:207], v[206:207], v[80:81], v[82:83] op_sel_hi:[1,0,0]
    v_pk_fma_f32 v[208:209], v[208:209], v[80:81], v[82:83] op_sel_hi:[1,0,0]
    v_pk_fma_f32 v[210:211], v[210:211], v[80:81], v[82:83] op_sel_hi:[1,0,0]
    v_pk_fma_f32 v[212:213], v[212:213], v[80:81], v[82:83] op_sel_hi:[1,0,0]
    v_pk_fma_f32 v[214:215], v[214:215], v[80:81], v[82:83] op_sel_hi:[1,0,0]
    v_cvt_pk_bf16_f32 v176, v200, v201
    v_cvt_pk_bf16_f32 v177, v202, v203
    v_cvt_pk_bf16_f32 v178, v204, v205
    v_cvt_pk_bf16_f32 v179, v206, v207
    v_cvt_pk_bf16_f32 v180, v208, v209
    v_cvt_pk_bf16_f32 v181, v210, v211
    v_cvt_pk_bf16_f32 v182, v212, v213
    v_cvt_pk_bf16_f32 v183, v214, v215
    ds_write_b128 v6, v[176:179] offset:0
    ds_write_b128 v6, v[180:183] offset:512
    v_lshlrev_b32 v216, 16, v184
    v_and_b32 v217, 0xffff0000, v184
    v_lshlrev_b32 v218, 16, v185
    v_and_b32 v219, 0xffff0000, v185
    v_lshlrev_b32 v220, 16, v186
    v_and_b32 v221, 0xffff0000, v186
    v_lshlrev_b32 v222, 16, v187
    v_and_b32 v223, 0xffff0000, v187
    v_lshlrev_b32 v224, 16, v188
    v_and_b32 v225, 0xffff0000, v188
    v_lshlrev_b32 v226, 16, v189
    v_and_b32 v227, 0xffff0000, v189
    v_lshlrev_b32 v228, 16, v190
    v_and_b32 v229, 0xffff0000, v190
    v_lshlrev_b32 v230, 16, v191
    v_and_b32 v231, 0xffff0000, v191
    v_mul_f32 v86, -v68, v84
    v_pk_fma_f32 v[216:217], v[216:217], v[84:85], v[86:87] op_sel_hi:[1,0,0]
    v_pk_fma_f32 v[218:219], v[218:219], v[84:85], v[86:87] op_sel_hi:[1,0,0]
    v_pk_fma_f32 v[220:221], v[220:221], v[84:85], v[86:87] op_sel_hi:[1,0,0]
    v_pk_fma_f32 v[222:223], v[222:223], v[84:85], v[86:87] op_sel_hi:[1,0,0]
    v_pk_fma_f32 v[224:225], v[224:225], v[84:85], v[86:87] op_sel_hi:[1,0,0]
    v_pk_fma_f32 v[226:227], v[226:227], v[84:85], v[86:87] op_sel_hi:[1,0,0]
    v_pk_fma_f32 v[228:229], v[228:229], v[84:85], v[86:87] op_sel_hi:[1,0,0]
    v_pk_fma_f32 v[230:231], v[230:231], v[84:85], v[86:87] op_sel_hi:[1,0,0]
    v_cvt_pk_bf16_f32 v184, v216, v217
    v_cvt_pk_bf16_f32 v185, v218, v219
    v_cvt_pk_bf16_f32 v186, v220, v221
    v_cvt_pk_bf16_f32 v187, v222, v223
    v_cvt_pk_bf16_f32 v188, v224, v225
    v_cvt_pk_bf16_f32 v189, v226, v227
    v_cvt_pk_bf16_f32 v190, v228, v229
    v_cvt_pk_bf16_f32 v191, v230, v231
    ds_write_b128 v6, v[184:187] offset:2176
    ds_write_b128 v6, v[188:191] offset:2688
    v_readlane_b32 s10, v66, 0
    v_readlane_b32 s11, v66, 32
    v_readlane_b32 s12, v70, 0
    v_readlane_b32 s13, v70, 32
    s_waitcnt lgkmcnt(0)
    s_mul_i32 s96, s96, 0x9E3779B1
    s_add_u32 s96, s96, 0x7F4A7C15
    s_barrier
    ds_read_b64_tr_b16 v[200:201], v5 offset:0
    ds_read_b64_tr_b16 v[202:203], v5 offset:4352
    ds_read_b64_tr_b16 v[204:205], v5 offset:128
    ds_read_b64_tr_b16 v[206:207], v5 offset:4480
    ds_read_b64_tr_b16 v[208:209], v5 offset:256
    ds_read_b64_tr_b16 v[210:211], v5 offset:4608
    ds_read_b64_tr_b16 v[212:213], v5 offset:384
    ds_read_b64_tr_b16 v[214:215], v5 offset:4736
    v_writelane_b32 v57, s10, 0
    v_writelane_b32 v57, s11, 1
    v_writelane_b32 v57, s12, 2
    v_writelane_b32 v57, s13, 3
    v_lshlrev_b32 v7, 4, v1
    v_mov_b32 v56, s96
    v_lshlrev_b32 v58, 3, v1
    s_waitcnt lgkmcnt(6)
    buffer_store_dwordx4 v[200:203], v7, s[40:43], s68 offen offset:0 sc1
    s_waitcnt lgkmcnt(4)
    buffer_store_dwordx4 v[204:207], v7, s[40:43], s68 offen offset:1024 sc1
    s_waitcnt lgkmcnt(2)
    buffer_store_dwordx4 v[208:211], v7, s[40:43], s68 offen offset:2048 sc1
    s_waitcnt lgkmcnt(0)
    buffer_store_dwordx4 v[212:215], v7, s[40:43], s68 offen offset:3072 sc1
    s_cmp_ge_u32 s5, 24
    s_cbranch_scc0 L_pf
    s_lshl_b32 s97, s64, 1
    s_add_u32 m0, s97, 0
    s_add_u32 s98, s69, 0
    s_and_b32 s98, s98, 7
    s_lshl_b32 s97, s98, 7
    s_mul_i32 s98, s98, 196608
    buffer_load_dwordx4 v8, s[48:51], s97 offen offset:0 lds
    buffer_load_dwordx4 v9, s[48:51], s97 offen offset:1024 lds
    buffer_load_dwordx4 v10, s[48:51], s97 offen offset:2048 lds
    buffer_load_dwordx4 v11, s[48:51], s97 offen offset:3072 lds
    s_add_u32 m0, s64, 16384
    s_add_u32 s97, s98, s8
    buffer_load_dwordx4 v12, s[52:55], s97 offen offset:0 lds
    buffer_load_dwordx4 v13, s[52:55], s97 offen offset:1024 lds
    s_waitcnt vmcnt(6)
    s_mov_b64 exec, 0xf
    buffer_store_dwordx2 v[56:57], v58, s[40:43], s37 offen sc1
    s_mov_b64 exec, -1
    s_add_u32 m0, s64, 24576
    s_add_u32 s97, s98, s9
    buffer_load_dwordx4 v12, s[52:55], s97 offen offset:0 lds
    buffer_load_dwordx4 v13, s[52:55], s97 offen offset:1024 lds
    s_lshl_b32 s97, s64, 1
    s_add_u32 m0, s97, 32768
    s_add_u32 s98, s69, 1
    s_and_b32 s98, s98, 7
    s_lshl_b32 s97, s98, 7
    s_mul_i32 s98, s98, 196608
    buffer_load_dwordx4 v8, s[48:51], s97 offen offset:0 lds
    buffer_load_dwordx4 v9, s[48:51], s97 offen offset:1024 lds
    buffer_load_dwordx4 v10, s[48:51], s97 offen offset:2048 lds
    buffer_load_dwordx4 v11, s[48:51], s97 offen offset:3072 lds
    s_add_u32 m0, s64, 49152
    s_add_u32 s97, s98, s8
    buffer_load_dwordx4 v12, s[52:55], s97 offen offset:0 lds
    buffer_load_dwordx4 v13, s[52:55], s97 offen offset:1024 lds
    s_add_u32 m0, s64, 57344
    s_add_u32 s97, s98, s9
    buffer_load_dwordx4 v12, s[52:55], s97 offen offset:0 lds
    buffer_load_dwordx4 v13, s[52:55], s97 offen offset:1024 lds
    s_and_b32 s17, s5, 7
    s_lshr_b32 s16, s5, 3
    s_add_u32 s16, s16, s17
    s_add_u32 s16, s16, 1
    s_and_b32 s16, s16, 3
    s_lshl_b32 s14, s4, 2
    s_add_u32 s16, s16, s14
    s_add_u32 s44, s38, 6291456
    s_addc_u32 s45, s39, 0
    s_mov_b32 s46, 1409024
    s_mov_b32 s47, 0x20000
    v_lshrrev_b32 v134, 3, v1
    v_mul_u32_u24 v134, 1024, v134
    v_bfe_u32 v2, v1, 4, 1
    v_lshlrev_b32 v2, 2, v2
    v_xor_b32 v2, v2, v1
    v_and_b32 v2, 7, v2
    v_lshl_add_u32 v134, v2, 4, v134
    v_add_u32 v135, 7168, v134
    v_lshrrev_b32 v132, 3, v1
    v_mul_u32_u24 v132, 4096, v132
    v_bfe_u32 v2, v1, 4, 1
    v_lshlrev_b32 v2, 2, v2
    v_xor_b32 v2, v2, v1
    v_and_b32 v2, 7, v2
    v_lshl_add_u32 v132, v2, 4, v132
    v_add_u32 v133, 31744, v132
    s_mul_i32 s33, s3, 131072
    s_lshl_b32 s14, s17, 7
    s_add_u32 s33, s33, s14
    s_lshl_b32 s32, s16, 16
    s_lshl_b32 s14, s3, 13
    s_add_u32 s32, s32, s14
    s_add_u32 s32, s32, 2097152
    s_add_u32 s36, s14, 4194304
    s_mov_b32 s6, 0
    s_mul_i32 s18, s3, 360448
    s_mul_i32 s19, s3, 1441792
    s_lshl_b32 s14, s16, 7
    s_add_u32 s19, s19, s14
    v_lshrrev_b32 v2, 5, v1
    v_lshlrev_b32 v2, 13, v2
    v_and_b32 v3, 31, v1
    v_lshl_add_u32 v2, v3, 4, v2
    s_lshl_b32 s14, s17, 10
    v_add_u32 v128, s14, v2
    v_add_u32 v129, 512, v128
    v_lshlrev_b32 v130, 4, v1
    v_add_u32 v131, 32768, v130
    v_lshrrev_b32 v136, 5, v1
    v_lshlrev_b32 v136, 9, v136
    v_bfe_u32 v2, v1, 2, 2
    v_lshl_add_u32 v136, v2, 7, v136
    v_bfe_u32 v2, v1, 3, 1
    v_lshl_add_u32 v136, v2, 6, v136
    v_bfe_u32 v2, v1, 4, 1
    v_lshl_add_u32 v136, v2, 5, v136
    v_and_b32 v2, 3, v1
    v_lshl_add_u32 v136, v2, 3, v136
    v_add_u32 v136, s64, v136
    v_xor_b32 v137, 64, v136
    v_add_u32 v138, 65536, v136
    v_add_u32 v139, 65536, v137
    v_add_u32 v140, 131072, v136
    v_add_u32 v141, 131072, v137
    v_bfe_u32 v2, v1, 3, 2
    v_lshlrev_b32 v2, 6, v2
    v_and_b32 v3, 3, v1
    v_lshl_add_u32 v2, v3, 3, v2
    v_bfe_u32 v3, v1, 2, 1
    v_lshl_add_u32 v2, v3, 14, v2
    s_lshl_b32 s14, s16, 9
    s_add_u32 s14, s14, 11534336
    v_add_u32 v142, s14, v2
    v_add_u32 v143, 256, v142
    s_lshl_b32 s14, s16, 2
    s_add_u32 s14, s14, s3
    s_lshl_b32 s14, s14, 7
    s_add_u32 s14, s14, 11632640
    v_and_b32 v3, 1, v1
    v_lshl_add_u32 v144, v3, 6, s14
    s_lshl_b32 s14, s17, 13
    s_mul_i32 s15, s3, 1408
    s_add_u32 s14, s14, s15
    s_add_u32 s14, s14, 11649024
    v_min_u32 v145, 21, v1
    v_lshl_add_u32 v145, v145, 6, s14
    v_accvgpr_write_b32 a200, v128
    v_accvgpr_write_b32 a201, v129
    v_accvgpr_write_b32 a202, v130
    v_accvgpr_write_b32 a203, v131
    v_accvgpr_write_b32 a204, v132
    v_accvgpr_write_b32 a205, v133
    v_accvgpr_write_b32 a206, v134
    v_accvgpr_write_b32 a207, v135
    v_accvgpr_write_b32 a208, v136
    v_accvgpr_write_b32 a209, v137
    v_accvgpr_write_b32 a210, v138
    v_accvgpr_write_b32 a211, v139
    v_accvgpr_write_b32 a212, v140
    v_accvgpr_write_b32 a213, v141
    v_accvgpr_write_b32 a214, v142
    v_accvgpr_write_b32 a215, v143
    v_accvgpr_write_b32 a216, v144
    v_accvgpr_write_b32 a217, v145
    v_and_b32 v6, 31, v1
    s_and_b32 s12, s3, 1
    s_lshl_b32 s12, s12, 6
    v_add_u32 v6, s12, v6
    v_bfe_u32 v7, v6, 1, 3
    v_lshrrev_b32 v14, 5, v1
    v_xor_b32 v7, v7, v14
    v_lshlrev_b32 v7, 4, v7
    v_lshl_add_u32 v14, v6, 7, v7
    v_xor_b32 v15, 32, v14
    v_xor_b32 v16, 64, v14
    v_xor_b32 v17, 96, v14
    v_add_u32 v18, 0x10000, v14
    v_add_u32 v19, 0x10000, v15
    v_add_u32 v20, 0x10000, v16
    v_add_u32 v21, 0x10000, v17
    v_lshrrev_b32 v22, 5, v1
    v_lshlrev_b32 v22, 10, v22
    v_bfe_u32 v6, v1, 2, 2
    v_lshl_add_u32 v22, v6, 7, v22
    v_bfe_u32 v6, v1, 3, 1
    v_lshl_add_u32 v22, v6, 6, v22
    v_bfe_u32 v6, v1, 4, 1
    v_lshl_add_u32 v22, v6, 5, v22
    v_and_b32 v6, 3, v1
    v_lshl_add_u32 v22, v6, 3, v22
    s_lshr_b32 s12, s3, 1
    s_lshl_b32 s12, s12, 13
    v_add_u32 v22, s12, v22
    v_xor_b32 v23, 64, v22
    v_add_u32 v24, 0x10000, v22
    v_add_u32 v25, 0x10000, v23
    s_sub_u32 s22, s5, 24
    s_lshl_b32 s22, s22, 3
    s_add_u32 s22, s22, s4
    s_lshl_b32 s12, s3, 6
    s_add_u32 s22, s22, s12
    s_lshl_b32 s37, s22, 6
    s_add_u32 s37, s37, 11567104
    s_cmp_lt_u32 s22, 176
    s_mul_i32 s22, s22, 24576
    s_cselect_b32 s22, s22, 0x4000000
    s_add_u32 s22, s22, 16777216
    v_lshlrev_b32 v26, 4, v1
    v_mov_b32 v44, -1
    v_mov_b32 v45, -1
    v_mov_b32 v46, -1
    v_mov_b32 v47, -1
    s_mov_b32 s60, s28
    s_mov_b32 s61, s29
    s_mov_b32 s62, 5636096
    s_mov_b32 s63, 0x20000
    v_bfe_u32 v40, v1, 2, 3
    v_lshlrev_b32 v40, 12, v40
    v_and_b32 v41, 3, v1
    v_lshl_add_u32 v40, v41, 7, v40
    s_sub_u32 s66, s5, 24
    s_mul_i32 s65, s3, 1441792
    s_lshl_b32 s12, s4, 9
    s_add_u32 s65, s65, s12
    buffer_store_dwordx4 v[44:47], v26, s[40:43], s22 offen offset:0 sc1
    buffer_store_dwordx4 v[44:47], v26, s[40:43], s22 offen offset:1024 sc1
    buffer_store_dwordx4 v[44:47], v26, s[40:43], s22 offen offset:2048 sc1
    buffer_store_dwordx4 v[44:47], v26, s[40:43], s22 offen offset:3072 sc1
    s_add_u32 s22, s22, 4096
    buffer_store_dwordx4 v[44:47], v26, s[40:43], s22 offen offset:0 sc1
    buffer_store_dwordx4 v[44:47], v26, s[40:43], s22 offen offset:1024 sc1
    buffer_store_dwordx4 v[44:47], v26, s[40:43], s22 offen offset:2048 sc1
    buffer_store_dwordx4 v[44:47], v26, s[40:43], s22 offen offset:3072 sc1
    s_add_u32 s22, s22, 4096
    buffer_store_dwordx4 v[44:47], v26, s[40:43], s22 offen offset:0 sc1
    buffer_store_dwordx4 v[44:47], v26, s[40:43], s22 offen offset:1024 sc1
    buffer_store_dwordx4 v[44:47], v26, s[40:43], s22 offen offset:2048 sc1
    buffer_store_dwordx4 v[44:47], v26, s[40:43], s22 offen offset:3072 sc1
    s_add_u32 s22, s22, 4096
    buffer_store_dwordx4 v[44:47], v26, s[40:43], s22 offen offset:0 sc1
    buffer_store_dwordx4 v[44:47], v26, s[40:43], s22 offen offset:1024 sc1
    buffer_store_dwordx4 v[44:47], v26, s[40:43], s22 offen offset:2048 sc1
    buffer_store_dwordx4 v[44:47], v26, s[40:43], s22 offen offset:3072 sc1
    s_add_u32 s22, s22, 4096
    s_waitcnt vmcnt(24)
    s_barrier
    ds_read_b128 v[128:131], v14 offset:0
    ds_read_b128 v[132:135], v14 offset:4096
    ds_read_b64_tr_b16 v[136:137], v22 offset:16384
    ds_read_b64_tr_b16 v[138:139], v22 offset:16896
    ds_read_b64_tr_b16 v[140:141], v23 offset:16384
    ds_read_b64_tr_b16 v[142:143], v23 offset:16896
    ds_read_b128 v[144:147], v15 offset:0
    ds_read_b128 v[148:151], v15 offset:4096
    ds_read_b64_tr_b16 v[152:153], v22 offset:18432
    ds_read_b64_tr_b16 v[154:155], v22 offset:18944
    ds_read_b64_tr_b16 v[156:157], v23 offset:18432
    ds_read_b64_tr_b16 v[158:159], v23 offset:18944
    s_waitcnt lgkmcnt(6)
    v_mfma_f32_32x32x16_bf16 v[64:79], v[136:139], v[128:131], 0
    ds_read_b128 v[160:163], v16 offset:0
    ds_read_b128 v[164:167], v16 offset:4096
    s_lshl_b32 s97, s64, 1
    s_add_u32 m0, s97, 65536
    s_add_u32 s98, s69, 2
    s_and_b32 s98, s98, 7
    s_lshl_b32 s97, s98, 7
    s_mul_i32 s98, s98, 196608
    buffer_load_dwordx4 v8, s[48:51], s97 offen offset:0 lds
    v_mfma_f32_32x32x16_bf16 v[96:111], v[140:143], v[128:131], 0
    ds_read_b64_tr_b16 v[168:169], v22 offset:20480
    ds_read_b64_tr_b16 v[170:171], v22 offset:20992
    v_mfma_f32_32x32x16_bf16 v[80:95], v[136:139], v[132:135], 0
    buffer_load_dwordx4 v9, s[48:51], s97 offen offset:1024 lds
    ds_read_b64_tr_b16 v[172:173], v23 offset:20480
    v_mfma_f32_32x32x16_bf16 v[112:127], v[140:143], v[132:135], 0
    ds_read_b64_tr_b16 v[174:175], v23 offset:20992
    buffer_load_dwordx4 v10, s[48:51], s97 offen offset:2048 lds
    s_waitcnt lgkmcnt(6)
    v_mfma_f32_32x32x16_bf16 v[64:79], v[152:155], v[144:147], v[64:79]
    ds_read_b128 v[128:131], v17 offset:0
    ds_read_b128 v[132:135], v17 offset:4096
    buffer_load_dwordx4 v11, s[48:51], s97 offen offset:3072 lds
    v_mfma_f32_32x32x16_bf16 v[96:111], v[156:159], v[144:147], v[96:111]
    ds_read_b64_tr_b16 v[136:137], v22 offset:22528
    ds_read_b64_tr_b16 v[138:139], v22 offset:23040
    v_mfma_f32_32x32x16_bf16 v[80:95], v[152:155], v[148:151], v[80:95]
    s_add_u32 m0, s64, 81920
    s_add_u32 s97, s98, s8
    buffer_load_dwordx4 v12, s[52:55], s97 offen offset:0 lds
    ds_read_b64_tr_b16 v[140:141], v23 offset:22528
    v_mfma_f32_32x32x16_bf16 v[112:127], v[156:159], v[148:151], v[112:127]
    ds_read_b64_tr_b16 v[142:143], v23 offset:23040
    buffer_load_dwordx4 v13, s[52:55], s97 offen offset:1024 lds
    s_waitcnt lgkmcnt(6)
    v_mfma_f32_32x32x16_bf16 v[64:79], v[168:171], v[160:163], v[64:79]
    s_add_u32 m0, s64, 90112
    s_add_u32 s97, s98, s9
    buffer_load_dwordx4 v12, s[52:55], s97 offen offset:0 lds
    v_mfma_f32_32x32x16_bf16 v[96:111], v[172:175], v[160:163], v[96:111]
    buffer_load_dwordx4 v13, s[52:55], s97 offen offset:1024 lds
    s_lshl_b32 s97, s64, 1
    s_add_u32 m0, s97, 0
    s_add_u32 s98, s69, 3
    s_and_b32 s98, s98, 7
    s_lshl_b32 s97, s98, 7
    s_mul_i32 s98, s98, 196608
    s_waitcnt vmcnt(24) lgkmcnt(0)
    s_barrier
    v_mfma_f32_32x32x16_bf16 v[80:95], v[168:171], v[164:167], v[80:95]
    ds_read_b128 v[144:147], v14 offset:32768
    ds_read_b128 v[148:151], v14 offset:36864
    ds_read_b64_tr_b16 v[152:153], v22 offset:49152
    ds_read_b64_tr_b16 v[154:155], v22 offset:49664
    v_mfma_f32_32x32x16_bf16 v[112:127], v[172:175], v[164:167], v[112:127]
    ds_read_b64_tr_b16 v[156:157], v23 offset:49152
    ds_read_b64_tr_b16 v[158:159], v23 offset:49664
    buffer_load_dwordx4 v8, s[48:51], s97 offen offset:0 lds
    v_mfma_f32_32x32x16_bf16 v[64:79], v[136:139], v[128:131], v[64:79]
    ds_read_b128 v[160:163], v15 offset:32768
    ds_read_b128 v[164:167], v15 offset:36864
    v_mfma_f32_32x32x16_bf16 v[96:111], v[140:143], v[128:131], v[96:111]
    ds_read_b64_tr_b16 v[168:169], v22 offset:51200
    buffer_load_dwordx4 v9, s[48:51], s97 offen offset:1024 lds
    v_mfma_f32_32x32x16_bf16 v[80:95], v[136:139], v[132:135], v[80:95]
    ds_read_b64_tr_b16 v[170:171], v22 offset:51712
    ds_read_b64_tr_b16 v[172:173], v23 offset:51200
    v_mfma_f32_32x32x16_bf16 v[112:127], v[140:143], v[132:135], v[112:127]
    ds_read_b64_tr_b16 v[174:175], v23 offset:51712
    buffer_load_dwordx4 v10, s[48:51], s97 offen offset:2048 lds
    s_waitcnt lgkmcnt(6)
    v_mfma_f32_32x32x16_bf16 v[64:79], v[152:155], v[144:147], v[64:79]
    ds_read_b128 v[128:131], v16 offset:32768
    ds_read_b128 v[132:135], v16 offset:36864
    v_mfma_f32_32x32x16_bf16 v[96:111], v[156:159], v[144:147], v[96:111]
    ds_read_b64_tr_b16 v[136:137], v22 offset:53248
    buffer_load_dwordx4 v11, s[48:51], s97 offen offset:3072 lds
    v_mfma_f32_32x32x16_bf16 v[80:95], v[152:155], v[148:151], v[80:95]
    ds_read_b64_tr_b16 v[138:139], v22 offset:53760
    ds_read_b64_tr_b16 v[140:141], v23 offset:53248
    v_mfma_f32_32x32x16_bf16 v[112:127], v[156:159], v[148:151], v[112:127]
    ds_read_b64_tr_b16 v[142:143], v23 offset:53760
    s_add_u32 m0, s64, 16384
    s_add_u32 s97, s98, s8
    buffer_load_dwordx4 v12, s[52:55], s97 offen offset:0 lds
    s_waitcnt lgkmcnt(6)
    v_mfma_f32_32x32x16_bf16 v[64:79], v[168:171], v[160:163], v[64:79]
    ds_read_b128 v[144:147], v17 offset:32768
    ds_read_b128 v[148:151], v17 offset:36864
    v_mfma_f32_32x32x16_bf16 v[96:111], v[172:175], v[160:163], v[96:111]
    ds_read_b64_tr_b16 v[152:153], v22 offset:55296
    buffer_load_dwordx4 v13, s[52:55], s97 offen offset:1024 lds
    v_mfma_f32_32x32x16_bf16 v[80:95], v[168:171], v[164:167], v[80:95]
    ds_read_b64_tr_b16 v[154:155], v22 offset:55808
    ds_read_b64_tr_b16 v[156:157], v23 offset:55296
    v_mfma_f32_32x32x16_bf16 v[112:127], v[172:175], v[164:167], v[112:127]
    ds_read_b64_tr_b16 v[158:159], v23 offset:55808
    s_add_u32 m0, s64, 24576
    s_add_u32 s97, s98, s9
    buffer_load_dwordx4 v12, s[52:55], s97 offen offset:0 lds
    s_waitcnt lgkmcnt(6)
    v_mfma_f32_32x32x16_bf16 v[64:79], v[136:139], v[128:131], v[64:79]
    buffer_load_dwordx4 v13, s[52:55], s97 offen offset:1024 lds
    v_mfma_f32_32x32x16_bf16 v[96:111], v[140:143], v[128:131], v[96:111]
    s_lshl_b32 s97, s64, 1
    s_add_u32 m0, s97, 32768
    s_add_u32 s98, s69, 4
    s_and_b32 s98, s98, 7
    s_lshl_b32 s97, s98, 7
    s_mul_i32 s98, s98, 196608
    s_waitcnt vmcnt(8) lgkmcnt(0)
    s_barrier
    v_mfma_f32_32x32x16_bf16 v[80:95], v[136:139], v[132:135], v[80:95]
    ds_read_b128 v[160:163], v18 offset:0
    ds_read_b128 v[164:167], v18 offset:4096
    ds_read_b64_tr_b16 v[168:169], v24 offset:16384
    ds_read_b64_tr_b16 v[170:171], v24 offset:16896
    v_mfma_f32_32x32x16_bf16 v[112:127], v[140:143], v[132:135], v[112:127]
    ds_read_b64_tr_b16 v[172:173], v25 offset:16384
    ds_read_b64_tr_b16 v[174:175], v25 offset:16896
    buffer_load_dwordx4 v8, s[48:51], s97 offen offset:0 lds
    v_mfma_f32_32x32x16_bf16 v[64:79], v[152:155], v[144:147], v[64:79]
    ds_read_b128 v[128:131], v19 offset:0
    ds_read_b128 v[132:135], v19 offset:4096
    v_mfma_f32_32x32x16_bf16 v[96:111], v[156:159], v[144:147], v[96:111]
    ds_read_b64_tr_b16 v[136:137], v24 offset:18432
    buffer_load_dwordx4 v9, s[48:51], s97 offen offset:1024 lds
    v_mfma_f32_32x32x16_bf16 v[80:95], v[152:155], v[148:151], v[80:95]
    ds_read_b64_tr_b16 v[138:139], v24 offset:18944
    ds_read_b64_tr_b16 v[140:141], v25 offset:18432
    v_mfma_f32_32x32x16_bf16 v[112:127], v[156:159], v[148:151], v[112:127]
    ds_read_b64_tr_b16 v[142:143], v25 offset:18944
    buffer_load_dwordx4 v10, s[48:51], s97 offen offset:2048 lds
    s_waitcnt lgkmcnt(6)
    v_mfma_f32_32x32x16_bf16 v[64:79], v[168:171], v[160:163], v[64:79]
    ds_read_b128 v[144:147], v20 offset:0
    ds_read_b128 v[148:151], v20 offset:4096
    v_mfma_f32_32x32x16_bf16 v[96:111], v[172:175], v[160:163], v[96:111]
    ds_read_b64_tr_b16 v[152:153], v24 offset:20480
    buffer_load_dwordx4 v11, s[48:51], s97 offen offset:3072 lds
    v_mfma_f32_32x32x16_bf16 v[80:95], v[168:171], v[164:167], v[80:95]
    ds_read_b64_tr_b16 v[154:155], v24 offset:20992
    ds_read_b64_tr_b16 v[156:157], v25 offset:20480
    v_mfma_f32_32x32x16_bf16 v[112:127], v[172:175], v[164:167], v[112:127]
    ds_read_b64_tr_b16 v[158:159], v25 offset:20992
    s_add_u32 m0, s64, 49152
    s_add_u32 s97, s98, s8
    buffer_load_dwordx4 v12, s[52:55], s97 offen offset:0 lds
    s_waitcnt lgkmcnt(6)
    v_mfma_f32_32x32x16_bf16 v[64:79], v[136:139], v[128:131], v[64:79]
    ds_read_b128 v[160:163], v21 offset:0
    ds_read_b128 v[164:167], v21 offset:4096
    v_mfma_f32_32x32x16_bf16 v[96:111], v[140:143], v[128:131], v[96:111]
    ds_read_b64_tr_b16 v[168:169], v24 offset:22528
    buffer_load_dwordx4 v13, s[52:55], s97 offen offset:1024 lds
    v_mfma_f32_32x32x16_bf16 v[80:95], v[136:139], v[132:135], v[80:95]
    ds_read_b64_tr_b16 v[170:171], v24 offset:23040
    ds_read_b64_tr_b16 v[172:173], v25 offset:22528
    v_mfma_f32_32x32x16_bf16 v[112:127], v[140:143], v[132:135], v[112:127]
    ds_read_b64_tr_b16 v[174:175], v25 offset:23040
    s_add_u32 m0, s64, 57344
    s_add_u32 s97, s98, s9
    buffer_load_dwordx4 v12, s[52:55], s97 offen offset:0 lds
    s_waitcnt lgkmcnt(6)
    v_mfma_f32_32x32x16_bf16 v[64:79], v[152:155], v[144:147], v[64:79]
    buffer_load_dwordx4 v13, s[52:55], s97 offen offset:1024 lds
    v_mfma_f32_32x32x16_bf16 v[96:111], v[156:159], v[144:147], v[96:111]
    s_lshl_b32 s97, s64, 1
    s_add_u32 m0, s97, 65536
    s_add_u32 s98, s69, 5
    s_and_b32 s98, s98, 7
    s_lshl_b32 s97, s98, 7
    s_mul_i32 s98, s98, 196608
    s_waitcnt vmcnt(8) lgkmcnt(0)
    s_barrier
    v_mfma_f32_32x32x16_bf16 v[80:95], v[152:155], v[148:151], v[80:95]
    ds_read_b128 v[128:131], v14 offset:0
    ds_read_b128 v[132:135], v14 offset:4096
    ds_read_b64_tr_b16 v[136:137], v22 offset:16384
    ds_read_b64_tr_b16 v[138:139], v22 offset:16896
    v_mfma_f32_32x32x16_bf16 v[112:127], v[156:159], v[148:151], v[112:127]
    ds_read_b64_tr_b16 v[140:141], v23 offset:16384
    ds_read_b64_tr_b16 v[142:143], v23 offset:16896
    buffer_load_dwordx4 v8, s[48:51], s97 offen offset:0 lds
    v_mfma_f32_32x32x16_bf16 v[64:79], v[168:171], v[160:163], v[64:79]
    ds_read_b128 v[144:147], v15 offset:0
    ds_read_b128 v[148:151], v15 offset:4096
    v_mfma_f32_32x32x16_bf16 v[96:111], v[172:175], v[160:163], v[96:111]
    ds_read_b64_tr_b16 v[152:153], v22 offset:18432
    buffer_load_dwordx4 v9, s[48:51], s97 offen offset:1024 lds
    v_mfma_f32_32x32x16_bf16 v[80:95], v[168:171], v[164:167], v[80:95]
    ds_read_b64_tr_b16 v[154:155], v22 offset:18944
    ds_read_b64_tr_b16 v[156:157], v23 offset:18432
    v_mfma_f32_32x32x16_bf16 v[112:127], v[172:175], v[164:167], v[112:127]
    ds_read_b64_tr_b16 v[158:159], v23 offset:18944
    buffer_load_dwordx4 v10, s[48:51], s97 offen offset:2048 lds
    s_waitcnt lgkmcnt(6)
    v_mfma_f32_32x32x16_bf16 v[64:79], v[136:139], v[128:131], v[64:79]
    ds_read_b128 v[160:163], v16 offset:0
    ds_read_b128 v[164:167], v16 offset:4096
    v_mfma_f32_32x32x16_bf16 v[96:111], v[140:143], v[128:131], v[96:111]
    ds_read_b64_tr_b16 v[168:169], v22 offset:20480
    buffer_load_dwordx4 v11, s[48:51], s97 offen offset:3072 lds
    v_mfma_f32_32x32x16_bf16 v[80:95], v[136:139], v[132:135], v[80:95]
    ds_read_b64_tr_b16 v[170:171], v22 offset:20992
    ds_read_b64_tr_b16 v[172:173], v23 offset:20480
    v_mfma_f32_32x32x16_bf16 v[112:127], v[140:143], v[132:135], v[112:127]
    ds_read_b64_tr_b16 v[174:175], v23 offset:20992
    s_add_u32 m0, s64, 81920
    s_add_u32 s97, s98, s8
    buffer_load_dwordx4 v12, s[52:55], s97 offen offset:0 lds
    s_waitcnt lgkmcnt(6)
    v_mfma_f32_32x32x16_bf16 v[64:79], v[152:155], v[144:147], v[64:79]
    ds_read_b128 v[128:131], v17 offset:0
    ds_read_b128 v[132:135], v17 offset:4096
    v_mfma_f32_32x32x16_bf16 v[96:111], v[156:159], v[144:147], v[96:111]
    ds_read_b64_tr_b16 v[136:137], v22 offset:22528
    buffer_load_dwordx4 v13, s[52:55], s97 offen offset:1024 lds
    v_mfma_f32_32x32x16_bf16 v[80:95], v[152:155], v[148:151], v[80:95]
    ds_read_b64_tr_b16 v[138:139], v22 offset:23040
    ds_read_b64_tr_b16 v[140:141], v23 offset:22528
    v_mfma_f32_32x32x16_bf16 v[112:127], v[156:159], v[148:151], v[112:127]
    ds_read_b64_tr_b16 v[142:143], v23 offset:23040
    s_add_u32 m0, s64, 90112
    s_add_u32 s97, s98, s9
    buffer_load_dwordx4 v12, s[52:55], s97 offen offset:0 lds
    s_waitcnt lgkmcnt(6)
    v_mfma_f32_32x32x16_bf16 v[64:79], v[168:171], v[160:163], v[64:79]
    buffer_load_dwordx4 v13, s[52:55], s97 offen offset:1024 lds
    v_mfma_f32_32x32x16_bf16 v[96:111], v[172:175], v[160:163], v[96:111]
    s_lshl_b32 s97, s64, 1
    s_add_u32 m0, s97, 0
    s_add_u32 s98, s69, 6
    s_and_b32 s98, s98, 7
    s_lshl_b32 s97, s98, 7
    s_mul_i32 s98, s98, 196608
    s_waitcnt vmcnt(8) lgkmcnt(0)
    s_barrier
    v_mfma_f32_32x32x16_bf16 v[80:95], v[168:171], v[164:167], v[80:95]
    ds_read_b128 v[144:147], v14 offset:32768
    ds_read_b128 v[148:151], v14 offset:36864
    ds_read_b64_tr_b16 v[152:153], v22 offset:49152
    ds_read_b64_tr_b16 v[154:155], v22 offset:49664
    v_mfma_f32_32x32x16_bf16 v[112:127], v[172:175], v[164:167], v[112:127]
    ds_read_b64_tr_b16 v[156:157], v23 offset:49152
    ds_read_b64_tr_b16 v[158:159], v23 offset:49664
    buffer_load_dwordx4 v8, s[48:51], s97 offen offset:0 lds
    v_mfma_f32_32x32x16_bf16 v[64:79], v[136:139], v[128:131], v[64:79]
    ds_read_b128 v[160:163], v15 offset:32768
    ds_read_b128 v[164:167], v15 offset:36864
    v_mfma_f32_32x32x16_bf16 v[96:111], v[140:143], v[128:131], v[96:111]
    ds_read_b64_tr_b16 v[168:169], v22 offset:51200
    buffer_load_dwordx4 v9, s[48:51], s97 offen offset:1024 lds
    v_mfma_f32_32x32x16_bf16 v[80:95], v[136:139], v[132:135], v[80:95]
    ds_read_b64_tr_b16 v[170:171], v22 offset:51712
    ds_read_b64_tr_b16 v[172:173], v23 offset:51200
    v_mfma_f32_32x32x16_bf16 v[112:127], v[140:143], v[132:135], v[112:127]
    ds_read_b64_tr_b16 v[174:175], v23 offset:51712
    buffer_load_dwordx4 v10, s[48:51], s97 offen offset:2048 lds
    s_waitcnt lgkmcnt(6)
    v_mfma_f32_32x32x16_bf16 v[64:79], v[152:155], v[144:147], v[64:79]
    ds_read_b128 v[128:131], v16 offset:32768
    ds_read_b128 v[132:135], v16 offset:36864
    v_mfma_f32_32x32x16_bf16 v[96:111], v[156:159], v[144:147], v[96:111]
    ds_read_b64_tr_b16 v[136:137], v22 offset:53248
    buffer_load_dwordx4 v11, s[48:51], s97 offen offset:3072 lds
    v_mfma_f32_32x32x16_bf16 v[80:95], v[152:155], v[148:151], v[80:95]
    ds_read_b64_tr_b16 v[138:139], v22 offset:53760
    ds_read_b64_tr_b16 v[140:141], v23 offset:53248
    v_mfma_f32_32x32x16_bf16 v[112:127], v[156:159], v[148:151], v[112:127]
    ds_read_b64_tr_b16 v[142:143], v23 offset:53760
    s_add_u32 m0, s64, 16384
    s_add_u32 s97, s98, s8
    buffer_load_dwordx4 v12, s[52:55], s97 offen offset:0 lds
    s_waitcnt lgkmcnt(6)
    v_mfma_f32_32x32x16_bf16 v[64:79], v[168:171], v[160:163], v[64:79]
    ds_read_b128 v[144:147], v17 offset:32768
    ds_read_b128 v[148:151], v17 offset:36864
    v_mfma_f32_32x32x16_bf16 v[96:111], v[172:175], v[160:163], v[96:111]
    ds_read_b64_tr_b16 v[152:153], v22 offset:55296
    buffer_load_dwordx4 v13, s[52:55], s97 offen offset:1024 lds
    v_mfma_f32_32x32x16_bf16 v[80:95], v[168:171], v[164:167], v[80:95]
    ds_read_b64_tr_b16 v[154:155], v22 offset:55808
    ds_read_b64_tr_b16 v[156:157], v23 offset:55296
    v_mfma_f32_32x32x16_bf16 v[112:127], v[172:175], v[164:167], v[112:127]
    ds_read_b64_tr_b16 v[158:159], v23 offset:55808
    s_add_u32 m0, s64, 24576
    s_add_u32 s97, s98, s9
    buffer_load_dwordx4 v12, s[52:55], s97 offen offset:0 lds
    s_waitcnt lgkmcnt(6)
    v_mfma_f32_32x32x16_bf16 v[64:79], v[136:139], v[128:131], v[64:79]
    buffer_load_dwordx4 v13, s[52:55], s97 offen offset:1024 lds
    v_mfma_f32_32x32x16_bf16 v[96:111], v[140:143], v[128:131], v[96:111]
    s_lshl_b32 s97, s64, 1
    s_add_u32 m0, s97, 32768
    s_add_u32 s98, s69, 7
    s_and_b32 s98, s98, 7
    s_lshl_b32 s97, s98, 7
    s_mul_i32 s98, s98, 196608
    s_waitcnt vmcnt(8) lgkmcnt(0)
    s_barrier
    v_mfma_f32_32x32x16_bf16 v[80:95], v[136:139], v[132:135], v[80:95]
    ds_read_b128 v[160:163], v18 offset:0
    ds_read_b128 v[164:167], v18 offset:4096
    ds_read_b64_tr_b16 v[168:169], v24 offset:16384
    ds_read_b64_tr_b16 v[170:171], v24 offset:16896
    v_mfma_f32_32x32x16_bf16 v[112:127], v[140:143], v[132:135], v[112:127]
    ds_read_b64_tr_b16 v[172:173], v25 offset:16384
    ds_read_b64_tr_b16 v[174:175], v25 offset:16896
    buffer_load_dwordx4 v8, s[48:51], s97 offen offset:0 lds
    v_mfma_f32_32x32x16_bf16 v[64:79], v[152:155], v[144:147], v[64:79]
    ds_read_b128 v[128:131], v19 offset:0
    ds_read_b128 v[132:135], v19 offset:4096
    v_mfma_f32_32x32x16_bf16 v[96:111], v[156:159], v[144:147], v[96:111]
    ds_read_b64_tr_b16 v[136:137], v24 offset:18432
    buffer_load_dwordx4 v9, s[48:51], s97 offen offset:1024 lds
    v_mfma_f32_32x32x16_bf16 v[80:95], v[152:155], v[148:151], v[80:95]
    ds_read_b64_tr_b16 v[138:139], v24 offset:18944
    ds_read_b64_tr_b16 v[140:141], v25 offset:18432
    v_mfma_f32_32x32x16_bf16 v[112:127], v[156:159], v[148:151], v[112:127]
    ds_read_b64_tr_b16 v[142:143], v25 offset:18944
    buffer_load_dwordx4 v10, s[48:51], s97 offen offset:2048 lds
    s_waitcnt lgkmcnt(6)
    v_mfma_f32_32x32x16_bf16 v[64:79], v[168:171], v[160:163], v[64:79]
    ds_read_b128 v[144:147], v20 offset:0
    ds_read_b128 v[148:151], v20 offset:4096
    v_mfma_f32_32x32x16_bf16 v[96:111], v[172:175], v[160:163], v[96:111]
    ds_read_b64_tr_b16 v[152:153], v24 offset:20480
    buffer_load_dwordx4 v11, s[48:51], s97 offen offset:3072 lds
    v_mfma_f32_32x32x16_bf16 v[80:95], v[168:171], v[164:167], v[80:95]
    ds_read_b64_tr_b16 v[154:155], v24 offset:20992
    ds_read_b64_tr_b16 v[156:157], v25 offset:20480
    v_mfma_f32_32x32x16_bf16 v[112:127], v[172:175], v[164:167], v[112:127]
    ds_read_b64_tr_b16 v[158:159], v25 offset:20992
    s_add_u32 m0, s64, 49152
    s_add_u32 s97, s98, s8
    buffer_load_dwordx4 v12, s[52:55], s97 offen offset:0 lds
    s_waitcnt lgkmcnt(6)
    v_mfma_f32_32x32x16_bf16 v[64:79], v[136:139], v[128:131], v[64:79]
    ds_read_b128 v[160:163], v21 offset:0
    ds_read_b128 v[164:167], v21 offset:4096
    v_mfma_f32_32x32x16_bf16 v[96:111], v[140:143], v[128:131], v[96:111]
    ds_read_b64_tr_b16 v[168:169], v24 offset:22528
    buffer_load_dwordx4 v13, s[52:55], s97 offen offset:1024 lds
    v_mfma_f32_32x32x16_bf16 v[80:95], v[136:139], v[132:135], v[80:95]
    ds_read_b64_tr_b16 v[170:171], v24 offset:23040
    ds_read_b64_tr_b16 v[172:173], v25 offset:22528
    v_mfma_f32_32x32x16_bf16 v[112:127], v[140:143], v[132:135], v[112:127]
    ds_read_b64_tr_b16 v[174:175], v25 offset:23040
    s_add_u32 m0, s64, 57344
    s_add_u32 s97, s98, s9
    buffer_load_dwordx4 v12, s[52:55], s97 offen offset:0 lds
    s_waitcnt lgkmcnt(6)
    v_mfma_f32_32x32x16_bf16 v[64:79], v[152:155], v[144:147], v[64:79]
    buffer_load_dwordx4 v13, s[52:55], s97 offen offset:1024 lds
    v_mfma_f32_32x32x16_bf16 v[96:111], v[156:159], v[144:147], v[96:111]
    s_waitcnt vmcnt(8) lgkmcnt(0)
    s_barrier
    v_mfma_f32_32x32x16_bf16 v[80:95], v[152:155], v[148:151], v[80:95]
    ds_read_b128 v[128:131], v14 offset:0
    ds_read_b128 v[132:135], v14 offset:4096
    ds_read_b64_tr_b16 v[136:137], v22 offset:16384
    ds_read_b64_tr_b16 v[138:139], v22 offset:16896
    v_mfma_f32_32x32x16_bf16 v[112:127], v[156:159], v[148:151], v[112:127]
    ds_read_b64_tr_b16 v[140:141], v23 offset:16384
    ds_read_b64_tr_b16 v[142:143], v23 offset:16896
    buffer_store_dwordx4 v[44:47], v26, s[40:43], s22 offen offset:0 sc1
    v_mfma_f32_32x32x16_bf16 v[64:79], v[168:171], v[160:163], v[64:79]
    ds_read_b128 v[144:147], v15 offset:0
    ds_read_b128 v[148:151], v15 offset:4096
    v_mfma_f32_32x32x16_bf16 v[96:111], v[172:175], v[160:163], v[96:111]
    ds_read_b64_tr_b16 v[152:153], v22 offset:18432
    buffer_store_dwordx4 v[44:47], v26, s[40:43], s22 offen offset:1024 sc1
    v_mfma_f32_32x32x16_bf16 v[80:95], v[168:171], v[164:167], v[80:95]
    ds_read_b64_tr_b16 v[154:155], v22 offset:18944
    ds_read_b64_tr_b16 v[156:157], v23 offset:18432
    v_mfma_f32_32x32x16_bf16 v[112:127], v[172:175], v[164:167], v[112:127]
    ds_read_b64_tr_b16 v[158:159], v23 offset:18944
    buffer_store_dwordx4 v[44:47], v26, s[40:43], s22 offen offset:2048 sc1
    s_waitcnt lgkmcnt(6)
    v_mfma_f32_32x32x16_bf16 v[64:79], v[136:139], v[128:131], v[64:79]
    ds_read_b128 v[160:163], v16 offset:0
    ds_read_b128 v[164:167], v16 offset:4096
    v_mfma_f32_32x32x16_bf16 v[96:111], v[140:143], v[128:131], v[96:111]
    ds_read_b64_tr_b16 v[168:169], v22 offset:20480
    buffer_store_dwordx4 v[44:47], v26, s[40:43], s22 offen offset:3072 sc1
    s_add_u32 s22, s22, 4096
    v_mfma_f32_32x32x16_bf16 v[80:95], v[136:139], v[132:135], v[80:95]
    ds_read_b64_tr_b16 v[170:171], v22 offset:20992
    ds_read_b64_tr_b16 v[172:173], v23 offset:20480
    v_mfma_f32_32x32x16_bf16 v[112:127], v[140:143], v[132:135], v[112:127]
    ds_read_b64_tr_b16 v[174:175], v23 offset:20992
    buffer_store_dwordx4 v[44:47], v26, s[40:43], s22 offen offset:0 sc1
    s_waitcnt lgkmcnt(6)
    v_mfma_f32_32x32x16_bf16 v[64:79], v[152:155], v[144:147], v[64:79]
    ds_read_b128 v[128:131], v17 offset:0
    ds_read_b128 v[132:135], v17 offset:4096
    v_mfma_f32_32x32x16_bf16 v[96:111], v[156:159], v[144:147], v[96:111]
    ds_read_b64_tr_b16 v[136:137], v22 offset:22528
    buffer_store_dwordx4 v[44:47], v26, s[40:43], s22 offen offset:1024 sc1
    v_mfma_f32_32x32x16_bf16 v[80:95], v[152:155], v[148:151], v[80:95]
    ds_read_b64_tr_b16 v[138:139], v22 offset:23040
    ds_read_b64_tr_b16 v[140:141], v23 offset:22528
    v_mfma_f32_32x32x16_bf16 v[112:127], v[156:159], v[148:151], v[112:127]
    ds_read_b64_tr_b16 v[142:143], v23 offset:23040
    buffer_store_dwordx4 v[44:47], v26, s[40:43], s22 offen offset:2048 sc1
    s_waitcnt lgkmcnt(6)
    v_mfma_f32_32x32x16_bf16 v[64:79], v[168:171], v[160:163], v[64:79]
    buffer_store_dwordx4 v[44:47], v26, s[40:43], s22 offen offset:3072 sc1
    s_add_u32 s22, s22, 4096
    s_add_u32 s67, s66, 8
    s_min_u32 s67, s67, 21
    s_lshl_b32 s67, s67, 16
    s_add_u32 s67, s67, s65
    s_add_u32 s67, s67, 0
    buffer_load_dword v63, v40, s[60:63], s67 offen
    v_mfma_f32_32x32x16_bf16 v[96:111], v[172:175], v[160:163], v[96:111]
    s_add_u32 s67, s66, 8
    s_min_u32 s67, s67, 21
    s_lshl_b32 s67, s67, 16
    s_add_u32 s67, s67, s65
    s_add_u32 s67, s67, 32768
    buffer_load_dword v63, v40, s[60:63], s67 offen
    s_waitcnt vmcnt(10) lgkmcnt(0)
    s_barrier
    v_mfma_f32_32x32x16_bf16 v[80:95], v[168:171], v[164:167], v[80:95]
    ds_read_b128 v[144:147], v14 offset:32768
    ds_read_b128 v[148:151], v14 offset:36864
    ds_read_b64_tr_b16 v[152:153], v22 offset:49152
    v_mfma_f32_32x32x16_bf16 v[112:127], v[172:175], v[164:167], v[112:127]
    ds_read_b64_tr_b16 v[154:155], v22 offset:49664
    ds_read_b64_tr_b16 v[156:157], v23 offset:49152
    ds_read_b64_tr_b16 v[158:159], v23 offset:49664
    v_mfma_f32_32x32x16_bf16 v[64:79], v[136:139], v[128:131], v[64:79]
    ds_read_b128 v[160:163], v15 offset:32768
    ds_read_b128 v[164:167], v15 offset:36864
    v_mfma_f32_32x32x16_bf16 v[96:111], v[140:143], v[128:131], v[96:111]
    ds_read_b64_tr_b16 v[168:169], v22 offset:51200
    v_mfma_f32_32x32x16_bf16 v[80:95], v[136:139], v[132:135], v[80:95]
    ds_read_b64_tr_b16 v[170:171], v22 offset:51712
    ds_read_b64_tr_b16 v[172:173], v23 offset:51200
    v_mfma_f32_32x32x16_bf16 v[112:127], v[140:143], v[132:135], v[112:127]
    ds_read_b64_tr_b16 v[174:175], v23 offset:51712
    s_waitcnt lgkmcnt(6)
    v_mfma_f32_32x32x16_bf16 v[64:79], v[152:155], v[144:147], v[64:79]
    ds_read_b128 v[128:131], v16 offset:32768
    ds_read_b128 v[132:135], v16 offset:36864
    v_mfma_f32_32x32x16_bf16 v[96:111], v[156:159], v[144:147], v[96:111]
    ds_read_b64_tr_b16 v[136:137], v22 offset:53248
    v_mfma_f32_32x32x16_bf16 v[80:95], v[152:155], v[148:151], v[80:95]
    ds_read_b64_tr_b16 v[138:139], v22 offset:53760
    ds_read_b64_tr_b16 v[140:141], v23 offset:53248
    v_mfma_f32_32x32x16_bf16 v[112:127], v[156:159], v[148:151], v[112:127]
    ds_read_b64_tr_b16 v[142:143], v23 offset:53760
    s_waitcnt lgkmcnt(6)
    v_mfma_f32_32x32x16_bf16 v[64:79], v[168:171], v[160:163], v[64:79]
    ds_read_b128 v[144:147], v17 offset:32768
    ds_read_b128 v[148:151], v17 offset:36864
    v_mfma_f32_32x32x16_bf16 v[96:111], v[172:175], v[160:163], v[96:111]
    ds_read_b64_tr_b16 v[152:153], v22 offset:55296
    v_mfma_f32_32x32x16_bf16 v[80:95], v[168:171], v[164:167], v[80:95]
    ds_read_b64_tr_b16 v[154:155], v22 offset:55808
    ds_read_b64_tr_b16 v[156:157], v23 offset:55296
    v_mfma_f32_32x32x16_bf16 v[112:127], v[172:175], v[164:167], v[112:127]
    ds_read_b64_tr_b16 v[158:159], v23 offset:55808
    s_waitcnt lgkmcnt(6)
    v_mfma_f32_32x32x16_bf16 v[64:79], v[136:139], v[128:131], v[64:79]
    v_mfma_f32_32x32x16_bf16 v[96:111], v[140:143], v[128:131], v[96:111]
    s_waitcnt lgkmcnt(0)
    s_barrier
    v_mfma_f32_32x32x16_bf16 v[80:95], v[136:139], v[132:135], v[80:95]
    v_mfma_f32_32x32x16_bf16 v[112:127], v[140:143], v[132:135], v[112:127]
    v_mfma_f32_32x32x16_bf16 v[64:79], v[152:155], v[144:147], v[64:79]
    v_mfma_f32_32x32x16_bf16 v[96:111], v[156:159], v[144:147], v[96:111]
    v_mfma_f32_32x32x16_bf16 v[80:95], v[152:155], v[148:151], v[80:95]
    v_mfma_f32_32x32x16_bf16 v[112:127], v[156:159], v[148:151], v[112:127]
    s_mov_b32 s10, 0x3fb8aa3b
    s_mov_b32 s11, s10
    s_mov_b32 s12, 0x358637bd
    s_lshl_b32 s14, s7, 1
    s_and_b32 s15, s3, 1
    s_add_u32 s14, s14, s15
    s_lshl_b32 s8, s70, 1
    s_lshr_b32 s9, s3, 1
    s_add_u32 s15, s8, s9
    s_lshl_b32 s8, s14, 16
    s_lshl_b32 s9, s15, 12
    s_add_u32 s8, s8, s9
    s_add_u32 s8, s8, 2097152
    s_add_u32 s9, s8, 32768
    s_lshl_b32 s71, s14, 3
    s_add_u32 s71, s71, s15
    s_lshl_b32 s71, s71, 6
    s_add_u32 s71, s71, 11632640
    v_lshlrev_b32 v7, 4, v1
    v_pk_mul_f32 v[176:177], v[64:65], s[10:11]
    v_pk_mul_f32 v[178:179], v[66:67], s[10:11]
    v_pk_mul_f32 v[180:181], v[68:69], s[10:11]
    v_pk_mul_f32 v[182:183], v[70:71], s[10:11]
    v_pk_mul_f32 v[184:185], v[72:73], s[10:11]
    v_pk_mul_f32 v[186:187], v[74:75], s[10:11]
    v_pk_mul_f32 v[188:189], v[76:77], s[10:11]
    v_pk_mul_f32 v[190:191], v[78:79], s[10:11]
    v_pk_mul_f32 v[192:193], v[80:81], s[10:11]
    v_pk_mul_f32 v[194:195], v[82:83], s[10:11]
    v_pk_mul_f32 v[196:197], v[84:85], s[10:11]
    v_pk_mul_f32 v[198:199], v[86:87], s[10:11]
    v_pk_mul_f32 v[200:201], v[88:89], s[10:11]
    v_pk_mul_f32 v[202:203], v[90:91], s[10:11]
    v_pk_mul_f32 v[204:205], v[92:93], s[10:11]
    v_pk_mul_f32 v[206:207], v[94:95], s[10:11]
    v_exp_f32_e64 v176, v176 clamp
    v_max_f32 v64, s12, v64
    v_exp_f32_e64 v177, v177 clamp
    v_max_f32 v65, s12, v65
    v_exp_f32_e64 v178, v178 clamp
    v_max_f32 v66, s12, v66
    v_exp_f32_e64 v179, v179 clamp
    v_max_f32 v67, s12, v67
    v_exp_f32_e64 v180, v180 clamp
    v_max_f32 v68, s12, v68
    v_exp_f32_e64 v181, v181 clamp
    v_max_f32 v69, s12, v69
    v_exp_f32_e64 v182, v182 clamp
    v_max_f32 v70, s12, v70
    v_exp_f32_e64 v183, v183 clamp
    v_max_f32 v71, s12, v71
    v_exp_f32_e64 v184, v184 clamp
    v_max_f32 v72, s12, v72
    v_exp_f32_e64 v185, v185 clamp
    v_max_f32 v73, s12, v73
    v_exp_f32_e64 v186, v186 clamp
    v_max_f32 v74, s12, v74
    v_exp_f32_e64 v187, v187 clamp
    v_max_f32 v75, s12, v75
    v_exp_f32_e64 v188, v188 clamp
    v_max_f32 v76, s12, v76
    v_exp_f32_e64 v189, v189 clamp
    v_max_f32 v77, s12, v77
    v_exp_f32_e64 v190, v190 clamp
    v_max_f32 v78, s12, v78
    v_exp_f32_e64 v191, v191 clamp
    v_max_f32 v79, s12, v79
    v_exp_f32_e64 v192, v192 clamp
    v_max_f32 v80, s12, v80
    v_exp_f32_e64 v193, v193 clamp
    v_max_f32 v81, s12, v81
    v_exp_f32_e64 v194, v194 clamp
    v_max_f32 v82, s12, v82
    v_exp_f32_e64 v195, v195 clamp
    v_max_f32 v83, s12, v83
    v_exp_f32_e64 v196, v196 clamp
    v_max_f32 v84, s12, v84
    v_exp_f32_e64 v197, v197 clamp
    v_max_f32 v85, s12, v85
    v_exp_f32_e64 v198, v198 clamp
    v_max_f32 v86, s12, v86
    v_exp_f32_e64 v199, v199 clamp
    v_max_f32 v87, s12, v87
    v_exp_f32_e64 v200, v200 clamp
    v_max_f32 v88, s12, v88
    v_exp_f32_e64 v201, v201 clamp
    v_max_f32 v89, s12, v89
    v_exp_f32_e64 v202, v202 clamp
    v_max_f32 v90, s12, v90
    v_exp_f32_e64 v203, v203 clamp
    v_max_f32 v91, s12, v91
    v_exp_f32_e64 v204, v204 clamp
    v_max_f32 v92, s12, v92
    v_exp_f32_e64 v205, v205 clamp
    v_max_f32 v93, s12, v93
    v_exp_f32_e64 v206, v206 clamp
    v_max_f32 v94, s12, v94
    v_exp_f32_e64 v207, v207 clamp
    v_max_f32 v95, s12, v95
    v_pk_add_f32 v[64:65], v[64:65], v[176:177]
    v_pk_add_f32 v[66:67], v[66:67], v[178:179]
    v_pk_add_f32 v[68:69], v[68:69], v[180:181]
    v_pk_add_f32 v[70:71], v[70:71], v[182:183]
    v_pk_add_f32 v[72:73], v[72:73], v[184:185]
    v_pk_add_f32 v[74:75], v[74:75], v[186:187]
    v_pk_add_f32 v[76:77], v[76:77], v[188:189]
    v_pk_add_f32 v[78:79], v[78:79], v[190:191]
    v_pk_add_f32 v[80:81], v[80:81], v[192:193]
    v_pk_add_f32 v[82:83], v[82:83], v[194:195]
    v_pk_add_f32 v[84:85], v[84:85], v[196:197]
    v_pk_add_f32 v[86:87], v[86:87], v[198:199]
    v_pk_add_f32 v[88:89], v[88:89], v[200:201]
    v_pk_add_f32 v[90:91], v[90:91], v[202:203]
    v_pk_add_f32 v[92:93], v[92:93], v[204:205]
    v_pk_add_f32 v[94:95], v[94:95], v[206:207]
    v_cvt_pk_bf16_f32 v128, v64, v65
    v_cvt_pk_bf16_f32 v129, v66, v67
    v_cvt_pk_bf16_f32 v130, v68, v69
    v_cvt_pk_bf16_f32 v131, v70, v71
    v_cvt_pk_bf16_f32 v132, v72, v73
    v_cvt_pk_bf16_f32 v133, v74, v75
    v_cvt_pk_bf16_f32 v134, v76, v77
    v_cvt_pk_bf16_f32 v135, v78, v79
    v_cvt_pk_bf16_f32 v136, v80, v81
    v_cvt_pk_bf16_f32 v137, v82, v83
    v_cvt_pk_bf16_f32 v138, v84, v85
    v_cvt_pk_bf16_f32 v139, v86, v87
    v_cvt_pk_bf16_f32 v140, v88, v89
    v_cvt_pk_bf16_f32 v141, v90, v91
    v_cvt_pk_bf16_f32 v142, v92, v93
    v_cvt_pk_bf16_f32 v143, v94, v95
    s_waitcnt vmcnt(2)
    v_mov_b32 v2, s96
    v_mov_b32 v3, 0
    s_mov_b64 exec, 1
    buffer_store_dword v2, v3, s[40:43], s37 offen sc1
    s_mov_b64 exec, -1
    buffer_store_dwordx4 v[128:131], v7, s[40:43], s8 offen offset:0 sc1
    buffer_store_dwordx4 v[132:135], v7, s[40:43], s8 offen offset:1024 sc1
    buffer_store_dwordx4 v[136:139], v7, s[40:43], s9 offen offset:0 sc1
    buffer_store_dwordx4 v[140:143], v7, s[40:43], s9 offen offset:1024 sc1
    v_pk_mul_f32 v[176:177], v[96:97], s[10:11]
    v_pk_mul_f32 v[178:179], v[98:99], s[10:11]
    v_pk_mul_f32 v[180:181], v[100:101], s[10:11]
    v_pk_mul_f32 v[182:183], v[102:103], s[10:11]
    v_pk_mul_f32 v[184:185], v[104:105], s[10:11]
    v_pk_mul_f32 v[186:187], v[106:107], s[10:11]
    v_pk_mul_f32 v[188:189], v[108:109], s[10:11]
    v_pk_mul_f32 v[190:191], v[110:111], s[10:11]
    v_pk_mul_f32 v[192:193], v[112:113], s[10:11]
    v_pk_mul_f32 v[194:195], v[114:115], s[10:11]
    v_pk_mul_f32 v[196:197], v[116:117], s[10:11]
    v_pk_mul_f32 v[198:199], v[118:119], s[10:11]
    v_pk_mul_f32 v[200:201], v[120:121], s[10:11]
    v_pk_mul_f32 v[202:203], v[122:123], s[10:11]
    v_pk_mul_f32 v[204:205], v[124:125], s[10:11]
    v_pk_mul_f32 v[206:207], v[126:127], s[10:11]
    v_exp_f32_e64 v176, v176 clamp
    v_max_f32 v96, s12, v96
    v_exp_f32_e64 v177, v177 clamp
    v_max_f32 v97, s12, v97
    v_exp_f32_e64 v178, v178 clamp
    v_max_f32 v98, s12, v98
    v_exp_f32_e64 v179, v179 clamp
    v_max_f32 v99, s12, v99
    v_exp_f32_e64 v180, v180 clamp
    v_max_f32 v100, s12, v100
    v_exp_f32_e64 v181, v181 clamp
    v_max_f32 v101, s12, v101
    v_exp_f32_e64 v182, v182 clamp
    v_max_f32 v102, s12, v102
    v_exp_f32_e64 v183, v183 clamp
    v_max_f32 v103, s12, v103
    v_exp_f32_e64 v184, v184 clamp
    v_max_f32 v104, s12, v104
    v_exp_f32_e64 v185, v185 clamp
    v_max_f32 v105, s12, v105
    v_exp_f32_e64 v186, v186 clamp
    v_max_f32 v106, s12, v106
    v_exp_f32_e64 v187, v187 clamp
    v_max_f32 v107, s12, v107
    v_exp_f32_e64 v188, v188 clamp
    v_max_f32 v108, s12, v108
    v_exp_f32_e64 v189, v189 clamp
    v_max_f32 v109, s12, v109
    v_exp_f32_e64 v190, v190 clamp
    v_max_f32 v110, s12, v110
    v_exp_f32_e64 v191, v191 clamp
    v_max_f32 v111, s12, v111
    v_exp_f32_e64 v192, v192 clamp
    v_max_f32 v112, s12, v112
    v_exp_f32_e64 v193, v193 clamp
    v_max_f32 v113, s12, v113
    v_exp_f32_e64 v194, v194 clamp
    v_max_f32 v114, s12, v114
    v_exp_f32_e64 v195, v195 clamp
    v_max_f32 v115, s12, v115
    v_exp_f32_e64 v196, v196 clamp
    v_max_f32 v116, s12, v116
    v_exp_f32_e64 v197, v197 clamp
    v_max_f32 v117, s12, v117
    v_exp_f32_e64 v198, v198 clamp
    v_max_f32 v118, s12, v118
    v_exp_f32_e64 v199, v199 clamp
    v_max_f32 v119, s12, v119
    v_exp_f32_e64 v200, v200 clamp
    v_max_f32 v120, s12, v120
    v_exp_f32_e64 v201, v201 clamp
    v_max_f32 v121, s12, v121
    v_exp_f32_e64 v202, v202 clamp
    v_max_f32 v122, s12, v122
    v_exp_f32_e64 v203, v203 clamp
    v_max_f32 v123, s12, v123
    v_exp_f32_e64 v204, v204 clamp
    v_max_f32 v124, s12, v124
    v_exp_f32_e64 v205, v205 clamp
    v_max_f32 v125, s12, v125
    v_exp_f32_e64 v206, v206 clamp
    v_max_f32 v126, s12, v126
    v_exp_f32_e64 v207, v207 clamp
    v_max_f32 v127, s12, v127
    v_pk_add_f32 v[96:97], v[96:97], v[176:177]
    v_pk_add_f32 v[98:99], v[98:99], v[178:179]
    v_pk_add_f32 v[100:101], v[100:101], v[180:181]
    v_pk_add_f32 v[102:103], v[102:103], v[182:183]
    v_pk_add_f32 v[104:105], v[104:105], v[184:185]
    v_pk_add_f32 v[106:107], v[106:107], v[186:187]
    v_pk_add_f32 v[108:109], v[108:109], v[188:189]
    v_pk_add_f32 v[110:111], v[110:111], v[190:191]
    v_pk_add_f32 v[112:113], v[112:113], v[192:193]
    v_pk_add_f32 v[114:115], v[114:115], v[194:195]
    v_pk_add_f32 v[116:117], v[116:117], v[196:197]
    v_pk_add_f32 v[118:119], v[118:119], v[198:199]
    v_pk_add_f32 v[120:121], v[120:121], v[200:201]
    v_pk_add_f32 v[122:123], v[122:123], v[202:203]
    v_pk_add_f32 v[124:125], v[124:125], v[204:205]
    v_pk_add_f32 v[126:127], v[126:127], v[206:207]
    v_cvt_pk_bf16_f32 v144, v96, v97
    v_cvt_pk_bf16_f32 v145, v98, v99
    v_cvt_pk_bf16_f32 v146, v100, v101
    v_cvt_pk_bf16_f32 v147, v102, v103
    v_cvt_pk_bf16_f32 v148, v104, v105
    v_cvt_pk_bf16_f32 v149, v106, v107
    v_cvt_pk_bf16_f32 v150, v108, v109
    v_cvt_pk_bf16_f32 v151, v110, v111
    v_cvt_pk_bf16_f32 v152, v112, v113
    v_cvt_pk_bf16_f32 v153, v114, v115
    v_cvt_pk_bf16_f32 v154, v116, v117
    v_cvt_pk_bf16_f32 v155, v118, v119
    v_cvt_pk_bf16_f32 v156, v120, v121
    v_cvt_pk_bf16_f32 v157, v122, v123
    v_cvt_pk_bf16_f32 v158, v124, v125
    v_cvt_pk_bf16_f32 v159, v126, v127
    buffer_store_dwordx4 v[144:147], v7, s[40:43], s8 offen offset:2048 sc1
    buffer_store_dwordx4 v[148:151], v7, s[40:43], s8 offen offset:3072 sc1
    buffer_store_dwordx4 v[152:155], v7, s[40:43], s9 offen offset:2048 sc1
    buffer_store_dwordx4 v[156:159], v7, s[40:43], s9 offen offset:3072 sc1
    s_mov_b32 s52, s20
    s_mov_b32 s53, s21
    s_mov_b32 s54, 524288
    s_mov_b32 s55, 0x20000
    s_mov_b32 s48, s28
    s_mov_b32 s49, s29
    s_mov_b32 s50, 5636096
    s_mov_b32 s51, 0x20000
    v_accvgpr_read_b32 v8, a200
    v_accvgpr_read_b32 v9, a201
    v_accvgpr_read_b32 v10, a202
    v_accvgpr_read_b32 v11, a203
    v_accvgpr_read_b32 v12, a204
    v_accvgpr_read_b32 v13, a205
    v_accvgpr_read_b32 v14, a206
    v_accvgpr_read_b32 v15, a207
    v_accvgpr_read_b32 v16, a208
    v_accvgpr_read_b32 v17, a209
    v_accvgpr_read_b32 v18, a210
    v_accvgpr_read_b32 v19, a211
    v_accvgpr_read_b32 v20, a212
    v_accvgpr_read_b32 v21, a213
    v_accvgpr_read_b32 v22, a214
    v_accvgpr_read_b32 v23, a215
    v_accvgpr_read_b32 v24, a216
    v_accvgpr_read_b32 v25, a217
    s_waitcnt vmcnt(0)
    v_mov_b32 v2, s96
    v_mov_b32 v3, 0
    s_mov_b64 exec, 1
    buffer_store_dword v2, v3, s[40:43], s71 offen sc1
    s_mov_b64 exec, -1
    s_barrier
    s_add_u32 s67, s66, 16
    s_min_u32 s67, s67, 21
    s_lshl_b32 s67, s67, 16
    s_add_u32 s67, s67, s65
    s_add_u32 s67, s67, 0
    buffer_load_dword v63, v40, s[60:63], s67 offen
    s_add_u32 s67, s66, 16
    s_min_u32 s67, s67, 21
    s_lshl_b32 s67, s67, 16
    s_add_u32 s67, s67, s65
    s_add_u32 s67, s67, 32768
    buffer_load_dword v63, v40, s[60:63], s67 offen
    s_mov_b32 s60, s30
    s_mov_b32 s61, s31
    s_mov_b32 s62, 4096
    s_mov_b32 s63, 0x20000
    s_lshl_b32 s14, s16, 7
    v_and_b32 v2, 31, v1
    v_lshlrev_b32 v2, 1, v2
    buffer_load_ushort v46, v2, s[60:63], s14 offen
    buffer_load_ushort v47, v2, s[60:63], s14 offen offset:64
    buffer_load_dword v62, v24, s[40:43], 0 offen sc1
    buffer_load_dwordx2 v[56:57], v22, s[40:43], 0 offen sc1
    buffer_load_dwordx2 v[58:59], v23, s[40:43], 0 offen sc1
    s_add_u32 m0, s64, 106496
    s_add_u32 s97, s33, 0
    buffer_load_dwordx4 v14, s[52:55], s97 offen lds
    buffer_load_dwordx4 v15, s[52:55], s97 offen offset:1024 lds
    s_add_u32 m0, s64, 114688
    s_add_u32 s97, s33, 16384
    buffer_load_dwordx4 v14, s[52:55], s97 offen lds
    buffer_load_dwordx4 v15, s[52:55], s97 offen offset:1024 lds
    s_add_u32 m0, s64, 122880
    s_add_u32 s97, s33, 32768
    buffer_load_dwordx4 v14, s[52:55], s97 offen lds
    buffer_load_dwordx4 v15, s[52:55], s97 offen offset:1024 lds
    s_add_u32 m0, s64, 131072
    s_add_u32 s97, s33, 49152
    buffer_load_dwordx4 v14, s[52:55], s97 offen lds
    buffer_load_dwordx4 v15, s[52:55], s97 offen offset:1024 lds
    s_add_u32 m0, s64, 139264
    s_add_u32 s97, s33, 65536
    buffer_load_dwordx4 v14, s[52:55], s97 offen lds
    buffer_load_dwordx4 v15, s[52:55], s97 offen offset:1024 lds
    s_add_u32 m0, s64, 147456
    s_add_u32 s97, s33, 81920
    buffer_load_dwordx4 v14, s[52:55], s97 offen lds
    buffer_load_dwordx4 v15, s[52:55], s97 offen offset:1024 lds
    s_add_u32 m0, s64, 155648
    s_add_u32 s97, s33, 98304
    buffer_load_dwordx4 v14, s[52:55], s97 offen lds
    buffer_load_dwordx4 v15, s[52:55], s97 offen offset:1024 lds
    s_add_u32 m0, s64, 98304
    s_add_u32 s97, s33, 114688
    buffer_load_dwordx4 v14, s[52:55], s97 offen lds
    buffer_load_dwordx4 v15, s[52:55], s97 offen offset:1024 lds
    s_add_u32 m0, s64, 32768
    s_add_u32 s97, s19, 0
    buffer_load_dwordx4 v12, s[48:51], s97 offen lds
    buffer_load_dwordx4 v13, s[48:51], s97 offen offset:1024 lds
    s_lshl_b32 s71, s2, 2
    s_add_u32 s71, s71, s3
    s_lshl_b32 s71, s71, 6
    s_add_u32 s71, s71, 11730944
    s_mov_b32 s70, 0
    s_waitcnt vmcnt(0) lgkmcnt(0)
    s_branch L_p2
L_a0:
    s_and_b32 s17, s5, 7
    s_lshr_b32 s16, s5, 3
    s_add_u32 s16, s16, s17
    s_add_u32 s16, s16, 1
    s_and_b32 s16, s16, 3
    s_lshl_b32 s14, s4, 2
    s_add_u32 s16, s16, s14
    s_add_u32 s44, s38, 6291456
    s_addc_u32 s45, s39, 0
    s_mov_b32 s46, 1409024
    s_mov_b32 s47, 0x20000
    v_lshrrev_b32 v134, 3, v1
    v_mul_u32_u24 v134, 1024, v134
    v_bfe_u32 v2, v1, 4, 1
    v_lshlrev_b32 v2, 2, v2
    v_xor_b32 v2, v2, v1
    v_and_b32 v2, 7, v2
    v_lshl_add_u32 v134, v2, 4, v134
    v_add_u32 v135, 7168, v134
    v_lshrrev_b32 v132, 3, v1
    v_mul_u32_u24 v132, 4096, v132
    v_bfe_u32 v2, v1, 4, 1
    v_lshlrev_b32 v2, 2, v2
    v_xor_b32 v2, v2, v1
    v_and_b32 v2, 7, v2
    v_lshl_add_u32 v132, v2, 4, v132
    v_add_u32 v133, 31744, v132
    s_mul_i32 s33, s3, 131072
    s_lshl_b32 s14, s17, 7
    s_add_u32 s33, s33, s14
    s_lshl_b32 s32, s16, 16
    s_lshl_b32 s14, s3, 13
    s_add_u32 s32, s32, s14
    s_add_u32 s32, s32, 2097152
    s_add_u32 s36, s14, 4194304
    s_mov_b32 s6, 0
    s_mul_i32 s18, s3, 360448
    s_mul_i32 s19, s3, 1441792
    s_lshl_b32 s14, s16, 7
    s_add_u32 s19, s19, s14
    v_lshrrev_b32 v2, 5, v1
    v_lshlrev_b32 v2, 13, v2
    v_and_b32 v3, 31, v1
    v_lshl_add_u32 v2, v3, 4, v2
    s_lshl_b32 s14, s17, 10
    v_add_u32 v128, s14, v2
    v_add_u32 v129, 512, v128
    v_lshlrev_b32 v130, 4, v1
    v_add_u32 v131, 32768, v130
    v_lshrrev_b32 v136, 5, v1
    v_lshlrev_b32 v136, 9, v136
    v_bfe_u32 v2, v1, 2, 2
    v_lshl_add_u32 v136, v2, 7, v136
    v_bfe_u32 v2, v1, 3, 1
    v_lshl_add_u32 v136, v2, 6, v136
    v_bfe_u32 v2, v1, 4, 1
    v_lshl_add_u32 v136, v2, 5, v136
    v_and_b32 v2, 3, v1
    v_lshl_add_u32 v136, v2, 3, v136
    v_add_u32 v136, s64, v136
    v_xor_b32 v137, 64, v136
    v_add_u32 v138, 65536, v136
    v_add_u32 v139, 65536, v137
    v_add_u32 v140, 131072, v136
    v_add_u32 v141, 131072, v137
    v_bfe_u32 v2, v1, 3, 2
    v_lshlrev_b32 v2, 6, v2
    v_and_b32 v3, 3, v1
    v_lshl_add_u32 v2, v3, 3, v2
    v_bfe_u32 v3, v1, 2, 1
    v_lshl_add_u32 v2, v3, 14, v2
    s_lshl_b32 s14, s16, 9
    s_add_u32 s14, s14, 11534336
    v_add_u32 v142, s14, v2
    v_add_u32 v143, 256, v142
    s_lshl_b32 s14, s16, 2
    s_add_u32 s14, s14, s3
    s_lshl_b32 s14, s14, 7
    s_add_u32 s14, s14, 11632640
    v_and_b32 v3, 1, v1
    v_lshl_add_u32 v144, v3, 6, s14
    s_lshl_b32 s14, s17, 13
    s_mul_i32 s15, s3, 1408
    s_add_u32 s14, s14, s15
    s_add_u32 s14, s14, 11649024
    v_min_u32 v145, 21, v1
    v_lshl_add_u32 v145, v145, 6, s14
    v_accvgpr_write_b32 a200, v128
    v_accvgpr_write_b32 a201, v129
    v_accvgpr_write_b32 a202, v130
    v_accvgpr_write_b32 a203, v131
    v_accvgpr_write_b32 a204, v132
    v_accvgpr_write_b32 a205, v133
    v_accvgpr_write_b32 a206, v134
    v_accvgpr_write_b32 a207, v135
    v_accvgpr_write_b32 a208, v136
    v_accvgpr_write_b32 a209, v137
    v_accvgpr_write_b32 a210, v138
    v_accvgpr_write_b32 a211, v139
    v_accvgpr_write_b32 a212, v140
    v_accvgpr_write_b32 a213, v141
    v_accvgpr_write_b32 a214, v142
    v_accvgpr_write_b32 a215, v143
    v_accvgpr_write_b32 a216, v144
    v_accvgpr_write_b32 a217, v145
    s_waitcnt lgkmcnt(0)
    s_mul_i32 s96, s96, 0x9E3779B1
    s_add_u32 s96, s96, 0x7F4A7C15
    s_and_b32 s66, s4, 1
    s_mul_i32 s66, s66, 22
    s_add_u32 s66, s66, s5
    s_lshr_b32 s65, s66, 2
    s_and_b32 s66, s66, 3
    s_lshl_b32 s23, s66, 1
    s_add_u32 s23, s23, s65
    v_lshlrev_b32 v26, 4, v1
    v_add_u32 v27, 6144, v26
    v_lshrrev_b32 v28, 3, v1
    v_mul_u32_u24 v28, 2752, v28
    v_bfe_u32 v3, v1, 4, 1
    v_lshlrev_b32 v3, 2, v3
    v_xor_b32 v3, v3, v1
    v_and_b32 v3, 7, v3
    v_lshl_add_u32 v28, v3, 4, v28
    v_add_u32 v29, 20992, v28
    s_lshr_b32 s10, s4, 1
    s_lshl_b32 s67, s10, 19
    s_lshl_b32 s11, s3, 14
    s_add_u32 s67, s67, s11
    s_lshl_b32 s11, s66, 11
    s_add_u32 s67, s67, s11
    s_lshl_b32 s68, s10, 5
    s_add_u32 s68, s68, s3
    s_mul_i32 s68, s68, 44032
    s_lshl_b32 s11, s65, 8
    s_add_u32 s68, s68, s11
    v_lshrrev_b32 v2, 5, v1
    v_lshlrev_b32 v2, 11, v2
    v_and_b32 v3, 31, v1
    v_lshl_add_u32 v2, v3, 4, v2
    s_and_b32 s11, s3, 1
    s_lshl_b32 s11, s11, 10
    s_and_b32 s12, s10, 1
    s_lshl_b32 s12, s12, 9
    s_add_u32 s11, s11, s12
    v_add_u32 v32, s11, v2
    v_xor_b32 v33, 512, v32
    v_add_u32 v34, 0x10000, v32
    v_add_u32 v35, 0x10000, v33
    v_lshrrev_b32 v36, 5, v1
    v_lshlrev_b32 v36, 10, v36
    v_bfe_u32 v3, v1, 2, 2
    v_lshl_add_u32 v36, v3, 7, v36
    v_bfe_u32 v3, v1, 3, 1
    v_lshl_add_u32 v36, v3, 6, v36
    v_bfe_u32 v3, v1, 4, 1
    v_lshl_add_u32 v36, v3, 5, v36
    v_and_b32 v3, 3, v1
    v_lshl_add_u32 v36, v3, 3, v36
    s_lshr_b32 s11, s3, 1
    s_lshl_b32 s11, s11, 13
    s_lshr_b32 s12, s10, 1
    s_lshl_b32 s12, s12, 6
    v_xor_b32 v36, s12, v36
    v_add_u32 v36, s11, v36
    v_xor_b32 v37, 64, v36
    v_add_u32 v38, 0x10000, v36
    v_add_u32 v39, 0x10000, v37
    s_mov_b32 s60, s26
    s_mov_b32 s61, s27
    s_mov_b32 s62, 2752
    s_mov_b32 s63, 0x20000
    s_lshl_b32 s10, s10, 12
    s_add_u32 s10, s10, 11534336
    s_lshr_b32 s11, s66, 1
    s_lshl_b32 s11, s11, 14
    s_add_u32 s10, s10, s11
    v_lshlrev_b32 v30, 6, v1
    v_add_u32 v30, s10, v30
    v_lshrrev_b32 v2, 5, v1
    v_lshlrev_b32 v2, 3, v2
    s_lshl_b32 s97, s65, 8
    s_lshr_b32 s98, s3, 1
    s_lshl_b32 s98, s98, 7
    s_add_u32 s97, s97, s98
    s_lshr_b32 s98, s4, 2
    s_lshl_b32 s98, s98, 6
    s_add_u32 s97, s97, s98
    buffer_load_dwordx2 v[48:49], v2, s[60:63], s97 offen offset:0
    buffer_load_dwordx2 v[50:51], v2, s[60:63], s97 offen offset:16
    buffer_load_dwordx2 v[52:53], v2, s[60:63], s97 offen offset:32
    buffer_load_dwordx2 v[54:55], v2, s[60:63], s97 offen offset:48
    s_waitcnt vmcnt(12)
    s_barrier
    ds_read_b128 v[128:131], v14 offset:0
    ds_read_b128 v[132:135], v14 offset:4096
    ds_read_b64_tr_b16 v[136:137], v22 offset:16384
    ds_read_b64_tr_b16 v[138:139], v22 offset:16896
    ds_read_b64_tr_b16 v[140:141], v23 offset:16384
    ds_read_b64_tr_b16 v[142:143], v23 offset:16896
    ds_read_b128 v[144:147], v15 offset:0
    ds_read_b128 v[148:151], v15 offset:4096
    ds_read_b64_tr_b16 v[152:153], v22 offset:18432
    ds_read_b64_tr_b16 v[154:155], v22 offset:18944
    ds_read_b64_tr_b16 v[156:157], v23 offset:18432
    ds_read_b64_tr_b16 v[158:159], v23 offset:18944
    s_waitcnt lgkmcnt(6)
    v_mfma_f32_32x32x16_bf16 v[64:79], v[128:131], v[136:139], 0
    ds_read_b128 v[160:163], v16 offset:0
    ds_read_b128 v[164:167], v16 offset:4096
    s_lshl_b32 s97, s64, 1
    s_add_u32 m0, s97, 65536
    s_add_u32 s98, s69, 2
    s_and_b32 s98, s98, 7
    s_lshl_b32 s97, s98, 7
    s_mul_i32 s98, s98, 196608
    buffer_load_dwordx4 v8, s[48:51], s97 offen offset:0 lds
    v_mfma_f32_32x32x16_bf16 v[96:111], v[128:131], v[140:143], 0
    ds_read_b64_tr_b16 v[168:169], v22 offset:20480
    ds_read_b64_tr_b16 v[170:171], v22 offset:20992
    v_mfma_f32_32x32x16_bf16 v[80:95], v[132:135], v[136:139], 0
    buffer_load_dwordx4 v9, s[48:51], s97 offen offset:1024 lds
    ds_read_b64_tr_b16 v[172:173], v23 offset:20480
    v_mfma_f32_32x32x16_bf16 v[112:127], v[132:135], v[140:143], 0
    ds_read_b64_tr_b16 v[174:175], v23 offset:20992
    buffer_load_dwordx4 v10, s[48:51], s97 offen offset:2048 lds
    s_waitcnt lgkmcnt(6)
    v_mfma_f32_32x32x16_bf16 v[64:79], v[144:147], v[152:155], v[64:79]
    ds_read_b128 v[128:131], v17 offset:0
    ds_read_b128 v[132:135], v17 offset:4096
    buffer_load_dwordx4 v11, s[48:51], s97 offen offset:3072 lds
    v_mfma_f32_32x32x16_bf16 v[96:111], v[144:147], v[156:159], v[96:111]
    ds_read_b64_tr_b16 v[136:137], v22 offset:22528
    ds_read_b64_tr_b16 v[138:139], v22 offset:23040
    v_mfma_f32_32x32x16_bf16 v[80:95], v[148:151], v[152:155], v[80:95]
    s_add_u32 m0, s64, 81920
    s_add_u32 s97, s98, s8
    buffer_load_dwordx4 v12, s[52:55], s97 offen offset:0 lds
    ds_read_b64_tr_b16 v[140:141], v23 offset:22528
    v_mfma_f32_32x32x16_bf16 v[112:127], v[148:151], v[156:159], v[112:127]
    ds_read_b64_tr_b16 v[142:143], v23 offset:23040
    buffer_load_dwordx4 v13, s[52:55], s97 offen offset:1024 lds
    s_waitcnt lgkmcnt(6)
    v_mfma_f32_32x32x16_bf16 v[64:79], v[160:163], v[168:171], v[64:79]
    s_add_u32 m0, s64, 90112
    s_add_u32 s97, s98, s9
    buffer_load_dwordx4 v12, s[52:55], s97 offen offset:0 lds
    v_mfma_f32_32x32x16_bf16 v[96:111], v[160:163], v[172:175], v[96:111]
    buffer_load_dwordx4 v13, s[52:55], s97 offen offset:1024 lds
    s_lshl_b32 s97, s64, 1
    s_add_u32 m0, s97, 0
    s_add_u32 s98, s69, 3
    s_and_b32 s98, s98, 7
    s_lshl_b32 s97, s98, 7
    s_mul_i32 s98, s98, 196608
    s_waitcnt vmcnt(12) lgkmcnt(0)
    s_barrier
    v_mfma_f32_32x32x16_bf16 v[80:95], v[164:167], v[168:171], v[80:95]
    ds_read_b128 v[144:147], v14 offset:32768
    ds_read_b128 v[148:151], v14 offset:36864
    ds_read_b64_tr_b16 v[152:153], v22 offset:49152
    ds_read_b64_tr_b16 v[154:155], v22 offset:49664
    v_mfma_f32_32x32x16_bf16 v[112:127], v[164:167], v[172:175], v[112:127]
    ds_read_b64_tr_b16 v[156:157], v23 offset:49152
    ds_read_b64_tr_b16 v[158:159], v23 offset:49664
    buffer_load_dwordx4 v8, s[48:51], s97 offen offset:0 lds
    v_mfma_f32_32x32x16_bf16 v[64:79], v[128:131], v[136:139], v[64:79]
    ds_read_b128 v[160:163], v15 offset:32768
    ds_read_b128 v[164:167], v15 offset:36864
    v_mfma_f32_32x32x16_bf16 v[96:111], v[128:131], v[140:143], v[96:111]
    ds_read_b64_tr_b16 v[168:169], v22 offset:51200
    buffer_load_dwordx4 v9, s[48:51], s97 offen offset:1024 lds
    v_mfma_f32_32x32x16_bf16 v[80:95], v[132:135], v[136:139], v[80:95]
    ds_read_b64_tr_b16 v[170:171], v22 offset:51712
    ds_read_b64_tr_b16 v[172:173], v23 offset:51200
    v_mfma_f32_32x32x16_bf16 v[112:127], v[132:135], v[140:143], v[112:127]
    ds_read_b64_tr_b16 v[174:175], v23 offset:51712
    buffer_load_dwordx4 v10, s[48:51], s97 offen offset:2048 lds
    s_waitcnt lgkmcnt(6)
    v_mfma_f32_32x32x16_bf16 v[64:79], v[144:147], v[152:155], v[64:79]
    ds_read_b128 v[128:131], v16 offset:32768
    ds_read_b128 v[132:135], v16 offset:36864
    v_mfma_f32_32x32x16_bf16 v[96:111], v[144:147], v[156:159], v[96:111]
    ds_read_b64_tr_b16 v[136:137], v22 offset:53248
    buffer_load_dwordx4 v11, s[48:51], s97 offen offset:3072 lds
    v_mfma_f32_32x32x16_bf16 v[80:95], v[148:151], v[152:155], v[80:95]
    ds_read_b64_tr_b16 v[138:139], v22 offset:53760
    ds_read_b64_tr_b16 v[140:141], v23 offset:53248
    v_mfma_f32_32x32x16_bf16 v[112:127], v[148:151], v[156:159], v[112:127]
    ds_read_b64_tr_b16 v[142:143], v23 offset:53760
    s_add_u32 m0, s64, 16384
    s_add_u32 s97, s98, s8
    buffer_load_dwordx4 v12, s[52:55], s97 offen offset:0 lds
    s_waitcnt lgkmcnt(6)
    v_mfma_f32_32x32x16_bf16 v[64:79], v[160:163], v[168:171], v[64:79]
    ds_read_b128 v[144:147], v17 offset:32768
    ds_read_b128 v[148:151], v17 offset:36864
    v_mfma_f32_32x32x16_bf16 v[96:111], v[160:163], v[172:175], v[96:111]
    ds_read_b64_tr_b16 v[152:153], v22 offset:55296
    buffer_load_dwordx4 v13, s[52:55], s97 offen offset:1024 lds
    v_mfma_f32_32x32x16_bf16 v[80:95], v[164:167], v[168:171], v[80:95]
    ds_read_b64_tr_b16 v[154:155], v22 offset:55808
    ds_read_b64_tr_b16 v[156:157], v23 offset:55296
    v_mfma_f32_32x32x16_bf16 v[112:127], v[164:167], v[172:175], v[112:127]
    ds_read_b64_tr_b16 v[158:159], v23 offset:55808
    s_add_u32 m0, s64, 24576
    s_add_u32 s97, s98, s9
    buffer_load_dwordx4 v12, s[52:55], s97 offen offset:0 lds
    s_waitcnt lgkmcnt(6)
    v_mfma_f32_32x32x16_bf16 v[64:79], v[128:131], v[136:139], v[64:79]
    buffer_load_dwordx4 v13, s[52:55], s97 offen offset:1024 lds
    v_mfma_f32_32x32x16_bf16 v[96:111], v[128:131], v[140:143], v[96:111]
    s_lshl_b32 s97, s64, 1
    s_add_u32 m0, s97, 32768
    s_add_u32 s98, s69, 4
    s_and_b32 s98, s98, 7
    s_lshl_b32 s97, s98, 7
    s_mul_i32 s98, s98, 196608
    s_waitcnt vmcnt(8) lgkmcnt(0)
    s_barrier
    v_mfma_f32_32x32x16_bf16 v[80:95], v[132:135], v[136:139], v[80:95]
    ds_read_b128 v[160:163], v18 offset:0
    ds_read_b128 v[164:167], v18 offset:4096
    ds_read_b64_tr_b16 v[168:169], v24 offset:16384
    ds_read_b64_tr_b16 v[170:171], v24 offset:16896
    v_mfma_f32_32x32x16_bf16 v[112:127], v[132:135], v[140:143], v[112:127]
    ds_read_b64_tr_b16 v[172:173], v25 offset:16384
    ds_read_b64_tr_b16 v[174:175], v25 offset:16896
    buffer_load_dwordx4 v8, s[48:51], s97 offen offset:0 lds
    v_mfma_f32_32x32x16_bf16 v[64:79], v[144:147], v[152:155], v[64:79]
    ds_read_b128 v[128:131], v19 offset:0
    ds_read_b128 v[132:135], v19 offset:4096
    v_mfma_f32_32x32x16_bf16 v[96:111], v[144:147], v[156:159], v[96:111]
    ds_read_b64_tr_b16 v[136:137], v24 offset:18432
    buffer_load_dwordx4 v9, s[48:51], s97 offen offset:1024 lds
    v_mfma_f32_32x32x16_bf16 v[80:95], v[148:151], v[152:155], v[80:95]
    ds_read_b64_tr_b16 v[138:139], v24 offset:18944
    ds_read_b64_tr_b16 v[140:141], v25 offset:18432
    v_mfma_f32_32x32x16_bf16 v[112:127], v[148:151], v[156:159], v[112:127]
    ds_read_b64_tr_b16 v[142:143], v25 offset:18944
    buffer_load_dwordx4 v10, s[48:51], s97 offen offset:2048 lds
    s_waitcnt lgkmcnt(6)
    v_mfma_f32_32x32x16_bf16 v[64:79], v[160:163], v[168:171], v[64:79]
    ds_read_b128 v[144:147], v20 offset:0
    ds_read_b128 v[148:151], v20 offset:4096
    v_mfma_f32_32x32x16_bf16 v[96:111], v[160:163], v[172:175], v[96:111]
    ds_read_b64_tr_b16 v[152:153], v24 offset:20480
    buffer_load_dwordx4 v11, s[48:51], s97 offen offset:3072 lds
    v_mfma_f32_32x32x16_bf16 v[80:95], v[164:167], v[168:171], v[80:95]
    ds_read_b64_tr_b16 v[154:155], v24 offset:20992
    ds_read_b64_tr_b16 v[156:157], v25 offset:20480
    v_mfma_f32_32x32x16_bf16 v[112:127], v[164:167], v[172:175], v[112:127]
    ds_read_b64_tr_b16 v[158:159], v25 offset:20992
    s_add_u32 m0, s64, 49152
    s_add_u32 s97, s98, s8
    buffer_load_dwordx4 v12, s[52:55], s97 offen offset:0 lds
    s_waitcnt lgkmcnt(6)
    v_mfma_f32_32x32x16_bf16 v[64:79], v[128:131], v[136:139], v[64:79]
    ds_read_b128 v[160:163], v21 offset:0
    ds_read_b128 v[164:167], v21 offset:4096
    v_mfma_f32_32x32x16_bf16 v[96:111], v[128:131], v[140:143], v[96:111]
    ds_read_b64_tr_b16 v[168:169], v24 offset:22528
    buffer_load_dwordx4 v13, s[52:55], s97 offen offset:1024 lds
    v_mfma_f32_32x32x16_bf16 v[80:95], v[132:135], v[136:139], v[80:95]
    ds_read_b64_tr_b16 v[170:171], v24 offset:23040
    ds_read_b64_tr_b16 v[172:173], v25 offset:22528
    v_mfma_f32_32x32x16_bf16 v[112:127], v[132:135], v[140:143], v[112:127]
    ds_read_b64_tr_b16 v[174:175], v25 offset:23040
    s_add_u32 m0, s64, 57344
    s_add_u32 s97, s98, s9
    buffer_load_dwordx4 v12, s[52:55], s97 offen offset:0 lds
    s_waitcnt lgkmcnt(6)
    v_mfma_f32_32x32x16_bf16 v[64:79], v[144:147], v[152:155], v[64:79]
    buffer_load_dwordx4 v13, s[52:55], s97 offen offset:1024 lds
    v_mfma_f32_32x32x16_bf16 v[96:111], v[144:147], v[156:159], v[96:111]
    s_lshl_b32 s97, s64, 1
    s_add_u32 m0, s97, 65536
    s_add_u32 s98, s69, 5
    s_and_b32 s98, s98, 7
    s_lshl_b32 s97, s98, 7
    s_mul_i32 s98, s98, 196608
    s_waitcnt vmcnt(8) lgkmcnt(0)
    s_barrier
    v_mfma_f32_32x32x16_bf16 v[80:95], v[148:151], v[152:155], v[80:95]
    ds_read_b128 v[128:131], v14 offset:0
    ds_read_b128 v[132:135], v14 offset:4096
    ds_read_b64_tr_b16 v[136:137], v22 offset:16384
    ds_read_b64_tr_b16 v[138:139], v22 offset:16896
    v_mfma_f32_32x32x16_bf16 v[112:127], v[148:151], v[156:159], v[112:127]
    ds_read_b64_tr_b16 v[140:141], v23 offset:16384
    ds_read_b64_tr_b16 v[142:143], v23 offset:16896
    buffer_load_dwordx4 v8, s[48:51], s97 offen offset:0 lds
    v_mfma_f32_32x32x16_bf16 v[64:79], v[160:163], v[168:171], v[64:79]
    ds_read_b128 v[144:147], v15 offset:0
    ds_read_b128 v[148:151], v15 offset:4096
    v_mfma_f32_32x32x16_bf16 v[96:111], v[160:163], v[172:175], v[96:111]
    ds_read_b64_tr_b16 v[152:153], v22 offset:18432
    buffer_load_dwordx4 v9, s[48:51], s97 offen offset:1024 lds
    v_mfma_f32_32x32x16_bf16 v[80:95], v[164:167], v[168:171], v[80:95]
    ds_read_b64_tr_b16 v[154:155], v22 offset:18944
    ds_read_b64_tr_b16 v[156:157], v23 offset:18432
    v_mfma_f32_32x32x16_bf16 v[112:127], v[164:167], v[172:175], v[112:127]
    ds_read_b64_tr_b16 v[158:159], v23 offset:18944
    buffer_load_dwordx4 v10, s[48:51], s97 offen offset:2048 lds
    s_waitcnt lgkmcnt(6)
    v_mfma_f32_32x32x16_bf16 v[64:79], v[128:131], v[136:139], v[64:79]
    ds_read_b128 v[160:163], v16 offset:0
    ds_read_b128 v[164:167], v16 offset:4096
    v_mfma_f32_32x32x16_bf16 v[96:111], v[128:131], v[140:143], v[96:111]
    ds_read_b64_tr_b16 v[168:169], v22 offset:20480
    buffer_load_dwordx4 v11, s[48:51], s97 offen offset:3072 lds
    v_mfma_f32_32x32x16_bf16 v[80:95], v[132:135], v[136:139], v[80:95]
    ds_read_b64_tr_b16 v[170:171], v22 offset:20992
    ds_read_b64_tr_b16 v[172:173], v23 offset:20480
    v_mfma_f32_32x32x16_bf16 v[112:127], v[132:135], v[140:143], v[112:127]
    ds_read_b64_tr_b16 v[174:175], v23 offset:20992
    s_add_u32 m0, s64, 81920
    s_add_u32 s97, s98, s8
    buffer_load_dwordx4 v12, s[52:55], s97 offen offset:0 lds
    s_waitcnt lgkmcnt(6)
    v_mfma_f32_32x32x16_bf16 v[64:79], v[144:147], v[152:155], v[64:79]
    ds_read_b128 v[128:131], v17 offset:0
    ds_read_b128 v[132:135], v17 offset:4096
    v_mfma_f32_32x32x16_bf16 v[96:111], v[144:147], v[156:159], v[96:111]
    ds_read_b64_tr_b16 v[136:137], v22 offset:22528
    buffer_load_dwordx4 v13, s[52:55], s97 offen offset:1024 lds
    v_mfma_f32_32x32x16_bf16 v[80:95], v[148:151], v[152:155], v[80:95]
    ds_read_b64_tr_b16 v[138:139], v22 offset:23040
    ds_read_b64_tr_b16 v[140:141], v23 offset:22528
    v_mfma_f32_32x32x16_bf16 v[112:127], v[148:151], v[156:159], v[112:127]
    ds_read_b64_tr_b16 v[142:143], v23 offset:23040
    s_add_u32 m0, s64, 90112
    s_add_u32 s97, s98, s9
    buffer_load_dwordx4 v12, s[52:55], s97 offen offset:0 lds
    s_waitcnt lgkmcnt(6)
    v_mfma_f32_32x32x16_bf16 v[64:79], v[160:163], v[168:171], v[64:79]
    buffer_load_dwordx4 v13, s[52:55], s97 offen offset:1024 lds
    v_mfma_f32_32x32x16_bf16 v[96:111], v[160:163], v[172:175], v[96:111]
    s_lshl_b32 s97, s64, 1
    s_add_u32 m0, s97, 0
    s_add_u32 s98, s69, 6
    s_and_b32 s98, s98, 7
    s_lshl_b32 s97, s98, 7
    s_mul_i32 s98, s98, 196608
    s_waitcnt vmcnt(8) lgkmcnt(0)
    s_barrier
    v_mfma_f32_32x32x16_bf16 v[80:95], v[164:167], v[168:171], v[80:95]
    ds_read_b128 v[144:147], v14 offset:32768
    ds_read_b128 v[148:151], v14 offset:36864
    ds_read_b64_tr_b16 v[152:153], v22 offset:49152
    ds_read_b64_tr_b16 v[154:155], v22 offset:49664
    v_mfma_f32_32x32x16_bf16 v[112:127], v[164:167], v[172:175], v[112:127]
    ds_read_b64_tr_b16 v[156:157], v23 offset:49152
    ds_read_b64_tr_b16 v[158:159], v23 offset:49664
    buffer_load_dwordx4 v8, s[48:51], s97 offen offset:0 lds
    v_mfma_f32_32x32x16_bf16 v[64:79], v[128:131], v[136:139], v[64:79]
    ds_read_b128 v[160:163], v15 offset:32768
    ds_read_b128 v[164:167], v15 offset:36864
    v_mfma_f32_32x32x16_bf16 v[96:111], v[128:131], v[140:143], v[96:111]
    ds_read_b64_tr_b16 v[168:169], v22 offset:51200
    buffer_load_dwordx4 v9, s[48:51], s97 offen offset:1024 lds
    v_mfma_f32_32x32x16_bf16 v[80:95], v[132:135], v[136:139], v[80:95]
    ds_read_b64_tr_b16 v[170:171], v22 offset:51712
    ds_read_b64_tr_b16 v[172:173], v23 offset:51200
    v_mfma_f32_32x32x16_bf16 v[112:127], v[132:135], v[140:143], v[112:127]
    ds_read_b64_tr_b16 v[174:175], v23 offset:51712
    buffer_load_dwordx4 v10, s[48:51], s97 offen offset:2048 lds
    s_waitcnt lgkmcnt(6)
    v_mfma_f32_32x32x16_bf16 v[64:79], v[144:147], v[152:155], v[64:79]
    ds_read_b128 v[128:131], v16 offset:32768
    ds_read_b128 v[132:135], v16 offset:36864
    v_mfma_f32_32x32x16_bf16 v[96:111], v[144:147], v[156:159], v[96:111]
    ds_read_b64_tr_b16 v[136:137], v22 offset:53248
    buffer_load_dwordx4 v11, s[48:51], s97 offen offset:3072 lds
    v_mfma_f32_32x32x16_bf16 v[80:95], v[148:151], v[152:155], v[80:95]
    ds_read_b64_tr_b16 v[138:139], v22 offset:53760
    ds_read_b64_tr_b16 v[140:141], v23 offset:53248
    v_mfma_f32_32x32x16_bf16 v[112:127], v[148:151], v[156:159], v[112:127]
    ds_read_b64_tr_b16 v[142:143], v23 offset:53760
    s_add_u32 m0, s64, 16384
    s_add_u32 s97, s98, s8
    buffer_load_dwordx4 v12, s[52:55], s97 offen offset:0 lds
    s_waitcnt lgkmcnt(6)
    v_mfma_f32_32x32x16_bf16 v[64:79], v[160:163], v[168:171], v[64:79]
    ds_read_b128 v[144:147], v17 offset:32768
    ds_read_b128 v[148:151], v17 offset:36864
    v_mfma_f32_32x32x16_bf16 v[96:111], v[160:163], v[172:175], v[96:111]
    ds_read_b64_tr_b16 v[152:153], v22 offset:55296
    buffer_load_dwordx4 v13, s[52:55], s97 offen offset:1024 lds
    v_mfma_f32_32x32x16_bf16 v[80:95], v[164:167], v[168:171], v[80:95]
    ds_read_b64_tr_b16 v[154:155], v22 offset:55808
    ds_read_b64_tr_b16 v[156:157], v23 offset:55296
    v_mfma_f32_32x32x16_bf16 v[112:127], v[164:167], v[172:175], v[112:127]
    ds_read_b64_tr_b16 v[158:159], v23 offset:55808
    s_add_u32 m0, s64, 24576
    s_add_u32 s97, s98, s9
    buffer_load_dwordx4 v12, s[52:55], s97 offen offset:0 lds
    s_waitcnt lgkmcnt(6)
    v_mfma_f32_32x32x16_bf16 v[64:79], v[128:131], v[136:139], v[64:79]
    buffer_load_dwordx4 v13, s[52:55], s97 offen offset:1024 lds
    v_mfma_f32_32x32x16_bf16 v[96:111], v[128:131], v[140:143], v[96:111]
    buffer_load_dword v31, v30, s[40:43], 0 offen sc1
    s_lshl_b32 s97, s64, 1
    s_add_u32 m0, s97, 32768
    s_add_u32 s98, s69, 7
    s_and_b32 s98, s98, 7
    s_lshl_b32 s97, s98, 7
    s_mul_i32 s98, s98, 196608
    s_waitcnt vmcnt(9) lgkmcnt(0)
    s_barrier
    v_mfma_f32_32x32x16_bf16 v[80:95], v[132:135], v[136:139], v[80:95]
    ds_read_b128 v[160:163], v18 offset:0
    ds_read_b128 v[164:167], v18 offset:4096
    ds_read_b64_tr_b16 v[168:169], v24 offset:16384
    ds_read_b64_tr_b16 v[170:171], v24 offset:16896
    v_mfma_f32_32x32x16_bf16 v[112:127], v[132:135], v[140:143], v[112:127]
    ds_read_b64_tr_b16 v[172:173], v25 offset:16384
    ds_read_b64_tr_b16 v[174:175], v25 offset:16896
    buffer_load_dwordx4 v8, s[48:51], s97 offen offset:0 lds
    v_mfma_f32_32x32x16_bf16 v[64:79], v[144:147], v[152:155], v[64:79]
    ds_read_b128 v[128:131], v19 offset:0
    ds_read_b128 v[132:135], v19 offset:4096
    buffer_load_dwordx4 v9, s[48:51], s97 offen offset:1024 lds
    v_mfma_f32_32x32x16_bf16 v[96:111], v[144:147], v[156:159], v[96:111]
    ds_read_b64_tr_b16 v[136:137], v24 offset:18432
    ds_read_b64_tr_b16 v[138:139], v24 offset:18944
    v_mfma_f32_32x32x16_bf16 v[80:95], v[148:151], v[152:155], v[80:95]
    buffer_load_dwordx4 v10, s[48:51], s97 offen offset:2048 lds
    ds_read_b64_tr_b16 v[140:141], v25 offset:18432
    v_mfma_f32_32x32x16_bf16 v[112:127], v[148:151], v[156:159], v[112:127]
    ds_read_b64_tr_b16 v[142:143], v25 offset:18944
    v_lshlrev_b32 v240, 16, v48
    v_and_b32 v241, 0xffff0000, v48
    v_lshlrev_b32 v242, 16, v49
    v_and_b32 v243, 0xffff0000, v49
    s_waitcnt lgkmcnt(6)
    v_mfma_f32_32x32x16_bf16 v[64:79], v[160:163], v[168:171], v[64:79]
    ds_read_b128 v[144:147], v20 offset:0
    ds_read_b128 v[148:151], v20 offset:4096
    buffer_load_dwordx4 v11, s[48:51], s97 offen offset:3072 lds
    v_mfma_f32_32x32x16_bf16 v[96:111], v[160:163], v[172:175], v[96:111]
    ds_read_b64_tr_b16 v[152:153], v24 offset:20480
    ds_read_b64_tr_b16 v[154:155], v24 offset:20992
    v_mfma_f32_32x32x16_bf16 v[80:95], v[164:167], v[168:171], v[80:95]
    s_add_u32 m0, s64, 49152
    s_add_u32 s97, s98, s8
    buffer_load_dwordx4 v12, s[52:55], s97 offen offset:0 lds
    ds_read_b64_tr_b16 v[156:157], v25 offset:20480
    v_mfma_f32_32x32x16_bf16 v[112:127], v[164:167], v[172:175], v[112:127]
    ds_read_b64_tr_b16 v[158:159], v25 offset:20992
    v_lshlrev_b32 v244, 16, v50
    v_and_b32 v245, 0xffff0000, v50
    v_lshlrev_b32 v246, 16, v51
    v_and_b32 v247, 0xffff0000, v51
    s_waitcnt lgkmcnt(6)
    v_mfma_f32_32x32x16_bf16 v[64:79], v[128:131], v[136:139], v[64:79]
    ds_read_b128 v[160:163], v21 offset:0
    ds_read_b128 v[164:167], v21 offset:4096
    buffer_load_dwordx4 v13, s[52:55], s97 offen offset:1024 lds
    v_mfma_f32_32x32x16_bf16 v[96:111], v[128:131], v[140:143], v[96:111]
    ds_read_b64_tr_b16 v[168:169], v24 offset:22528
    ds_read_b64_tr_b16 v[170:171], v24 offset:23040
    v_mfma_f32_32x32x16_bf16 v[80:95], v[132:135], v[136:139], v[80:95]
    s_add_u32 m0, s64, 57344
    s_add_u32 s97, s98, s9
    buffer_load_dwordx4 v12, s[52:55], s97 offen offset:0 lds
    ds_read_b64_tr_b16 v[172:173], v25 offset:22528
    v_mfma_f32_32x32x16_bf16 v[112:127], v[132:135], v[140:143], v[112:127]
    ds_read_b64_tr_b16 v[174:175], v25 offset:23040
    v_lshlrev_b32 v248, 16, v52
    v_and_b32 v249, 0xffff0000, v52
    v_lshlrev_b32 v250, 16, v53
    v_and_b32 v251, 0xffff0000, v53
    s_waitcnt lgkmcnt(6)
    v_mfma_f32_32x32x16_bf16 v[64:79], v[144:147], v[152:155], v[64:79]
    buffer_load_dwordx4 v13, s[52:55], s97 offen offset:1024 lds
    v_mfma_f32_32x32x16_bf16 v[96:111], v[144:147], v[156:159], v[96:111]
    s_lshl_b32 s97, s64, 1
    s_add_u32 m0, s97, 65536
    s_add_u32 s98, s23, 0
    s_and_b32 s98, s98, 7
    s_lshl_b32 s97, s98, 16
    s_add_u32 s97, s97, s67
    s_mul_i32 s98, s98, 176128
    s_add_u32 s98, s98, s68
    s_waitcnt vmcnt(9) lgkmcnt(0)
    s_barrier
    s_waitcnt vmcnt(8)
    v_cmp_ne_u32 s[100:101], s96, v31
    s_mov_b32 s99, 0x40000
    s_cmp_eq_u64 s[100:101], 0
    s_cbranch_scc1 L_pd2
L_pl2:
    s_mov_b64 exec, s[100:101]
    buffer_load_dword v31, v30, s[40:43], 0 offen sc1
    s_waitcnt vmcnt(0)
    v_cmp_ne_u32 s[100:101], s96, v31
    s_sub_u32 s99, s99, 1
    s_cselect_b64 s[100:101], 0, s[100:101]
    s_cmp_eq_u64 s[100:101], 0
    s_cbranch_scc0 L_pl2
    s_mov_b64 exec, -1
L_pd2:
    v_mfma_f32_32x32x16_bf16 v[80:95], v[148:151], v[152:155], v[80:95]
    ds_read_b128 v[128:131], v14 offset:0
    ds_read_b128 v[132:135], v14 offset:4096
    ds_read_b64_tr_b16 v[136:137], v22 offset:16384
    ds_read_b64_tr_b16 v[138:139], v22 offset:16896
    v_mfma_f32_32x32x16_bf16 v[112:127], v[148:151], v[156:159], v[112:127]
    ds_read_b64_tr_b16 v[140:141], v23 offset:16384
    ds_read_b64_tr_b16 v[142:143], v23 offset:16896
    buffer_load_dwordx4 v26, s[40:43], s97 offen offset:0 sc1 lds
    v_mfma_f32_32x32x16_bf16 v[64:79], v[160:163], v[168:171], v[64:79]
    ds_read_b128 v[144:147], v15 offset:0
    ds_read_b128 v[148:151], v15 offset:4096
    buffer_load_dwordx4 v26, s[40:43], s97 offen offset:1024 sc1 lds
    v_mfma_f32_32x32x16_bf16 v[96:111], v[160:163], v[172:175], v[96:111]
    ds_read_b64_tr_b16 v[152:153], v22 offset:18432
    ds_read_b64_tr_b16 v[154:155], v22 offset:18944
    v_mfma_f32_32x32x16_bf16 v[80:95], v[164:167], v[168:171], v[80:95]
    buffer_load_dwordx4 v27, s[40:43], s97 offen offset:2048 sc1 lds
    ds_read_b64_tr_b16 v[156:157], v23 offset:18432
    v_mfma_f32_32x32x16_bf16 v[112:127], v[164:167], v[172:175], v[112:127]
    ds_read_b64_tr_b16 v[158:159], v23 offset:18944
    v_lshlrev_b32 v252, 16, v54
    v_and_b32 v253, 0xffff0000, v54
    v_lshlrev_b32 v254, 16, v55
    v_and_b32 v255, 0xffff0000, v55
    s_waitcnt lgkmcnt(6)
    v_mfma_f32_32x32x16_bf16 v[64:79], v[128:131], v[136:139], v[64:79]
    ds_read_b128 v[160:163], v16 offset:0
    ds_read_b128 v[164:167], v16 offset:4096
    v_mfma_f32_32x32x16_bf16 v[96:111], v[128:131], v[140:143], v[96:111]
    ds_read_b64_tr_b16 v[168:169], v22 offset:20480
    buffer_load_dwordx4 v27, s[40:43], s97 offen offset:3072 sc1 lds
    v_mfma_f32_32x32x16_bf16 v[80:95], v[132:135], v[136:139], v[80:95]
    ds_read_b64_tr_b16 v[170:171], v22 offset:20992
    ds_read_b64_tr_b16 v[172:173], v23 offset:20480
    v_mfma_f32_32x32x16_bf16 v[112:127], v[132:135], v[140:143], v[112:127]
    ds_read_b64_tr_b16 v[174:175], v23 offset:20992
    s_add_u32 m0, s64, 81920
    s_nop 0
    buffer_load_dwordx4 v28, s[56:59], s98 offen offset:0 lds
    s_waitcnt lgkmcnt(6)
    v_mfma_f32_32x32x16_bf16 v[64:79], v[144:147], v[152:155], v[64:79]
    ds_read_b128 v[128:131], v17 offset:0
    ds_read_b128 v[132:135], v17 offset:4096
    v_mfma_f32_32x32x16_bf16 v[96:111], v[144:147], v[156:159], v[96:111]
    ds_read_b64_tr_b16 v[136:137], v22 offset:22528
    s_add_u32 m0, s64, 89984
    s_nop 0
    buffer_load_dwordx4 v28, s[56:59], s98 offen offset:128 lds
    v_mfma_f32_32x32x16_bf16 v[80:95], v[148:151], v[152:155], v[80:95]
    ds_read_b64_tr_b16 v[138:139], v22 offset:23040
    ds_read_b64_tr_b16 v[140:141], v23 offset:22528
    v_mfma_f32_32x32x16_bf16 v[112:127], v[148:151], v[156:159], v[112:127]
    ds_read_b64_tr_b16 v[142:143], v23 offset:23040
    s_add_u32 m0, s64, 81920
    s_nop 0
    buffer_load_dwordx4 v29, s[56:59], s98 offen offset:1024 lds
    s_waitcnt lgkmcnt(6)
    v_mfma_f32_32x32x16_bf16 v[64:79], v[160:163], v[168:171], v[64:79]
    s_add_u32 m0, s64, 89984
    s_nop 0
    buffer_load_dwordx4 v29, s[56:59], s98 offen offset:1152 lds
    v_mfma_f32_32x32x16_bf16 v[96:111], v[160:163], v[172:175], v[96:111]
    s_lshl_b32 s97, s64, 1
    s_add_u32 m0, s97, 0
    s_add_u32 s98, s23, 1
    s_and_b32 s98, s98, 7
    s_lshl_b32 s97, s98, 16
    s_add_u32 s97, s97, s67
    s_mul_i32 s98, s98, 176128
    s_add_u32 s98, s98, s68
    s_waitcnt vmcnt(8) lgkmcnt(0)
    s_barrier
    v_mfma_f32_32x32x16_bf16 v[80:95], v[164:167], v[168:171], v[80:95]
    ds_read_b128 v[144:147], v14 offset:32768
    ds_read_b128 v[148:151], v14 offset:36864
    ds_read_b64_tr_b16 v[152:153], v22 offset:49152
    ds_read_b64_tr_b16 v[154:155], v22 offset:49664
    v_mfma_f32_32x32x16_bf16 v[112:127], v[164:167], v[172:175], v[112:127]
    ds_read_b64_tr_b16 v[156:157], v23 offset:49152
    ds_read_b64_tr_b16 v[158:159], v23 offset:49664
    buffer_load_dwordx4 v26, s[40:43], s97 offen offset:0 sc1 lds
    v_mfma_f32_32x32x16_bf16 v[64:79], v[128:131], v[136:139], v[64:79]
    ds_read_b128 v[160:163], v15 offset:32768
    ds_read_b128 v[164:167], v15 offset:36864
    v_mfma_f32_32x32x16_bf16 v[96:111], v[128:131], v[140:143], v[96:111]
    ds_read_b64_tr_b16 v[168:169], v22 offset:51200
    buffer_load_dwordx4 v26, s[40:43], s97 offen offset:1024 sc1 lds
    v_mfma_f32_32x32x16_bf16 v[80:95], v[132:135], v[136:139], v[80:95]
    ds_read_b64_tr_b16 v[170:171], v22 offset:51712
    ds_read_b64_tr_b16 v[172:173], v23 offset:51200
    v_mfma_f32_32x32x16_bf16 v[112:127], v[132:135], v[140:143], v[112:127]
    ds_read_b64_tr_b16 v[174:175], v23 offset:51712
    buffer_load_dwordx4 v27, s[40:43], s97 offen offset:2048 sc1 lds
    s_waitcnt lgkmcnt(6)
    v_mfma_f32_32x32x16_bf16 v[64:79], v[144:147], v[152:155], v[64:79]
    ds_read_b128 v[128:131], v16 offset:32768
    ds_read_b128 v[132:135], v16 offset:36864
    v_mfma_f32_32x32x16_bf16 v[96:111], v[144:147], v[156:159], v[96:111]
    ds_read_b64_tr_b16 v[136:137], v22 offset:53248
    buffer_load_dwordx4 v27, s[40:43], s97 offen offset:3072 sc1 lds
    v_mfma_f32_32x32x16_bf16 v[80:95], v[148:151], v[152:155], v[80:95]
    ds_read_b64_tr_b16 v[138:139], v22 offset:53760
    ds_read_b64_tr_b16 v[140:141], v23 offset:53248
    v_mfma_f32_32x32x16_bf16 v[112:127], v[148:151], v[156:159], v[112:127]
    ds_read_b64_tr_b16 v[142:143], v23 offset:53760
    s_add_u32 m0, s64, 16384
    s_nop 0
    buffer_load_dwordx4 v28, s[56:59], s98 offen offset:0 lds
    s_waitcnt lgkmcnt(6)
    v_mfma_f32_32x32x16_bf16 v[64:79], v[160:163], v[168:171], v[64:79]
    ds_read_b128 v[144:147], v17 offset:32768
    ds_read_b128 v[148:151], v17 offset:36864
    v_mfma_f32_32x32x16_bf16 v[96:111], v[160:163], v[172:175], v[96:111]
    ds_read_b64_tr_b16 v[152:153], v22 offset:55296
    s_add_u32 m0, s64, 24448
    s_nop 0
    buffer_load_dwordx4 v28, s[56:59], s98 offen offset:128 lds
    v_mfma_f32_32x32x16_bf16 v[80:95], v[164:167], v[168:171], v[80:95]
    ds_read_b64_tr_b16 v[154:155], v22 offset:55808
    ds_read_b64_tr_b16 v[156:157], v23 offset:55296
    v_mfma_f32_32x32x16_bf16 v[112:127], v[164:167], v[172:175], v[112:127]
    ds_read_b64_tr_b16 v[158:159], v23 offset:55808
    s_add_u32 m0, s64, 16384
    s_nop 0
    buffer_load_dwordx4 v29, s[56:59], s98 offen offset:1024 lds
    s_waitcnt lgkmcnt(6)
    v_mfma_f32_32x32x16_bf16 v[64:79], v[128:131], v[136:139], v[64:79]
    s_add_u32 m0, s64, 24448
    s_nop 0
    buffer_load_dwordx4 v29, s[56:59], s98 offen offset:1152 lds
    v_mfma_f32_32x32x16_bf16 v[96:111], v[128:131], v[140:143], v[96:111]
    s_lshl_b32 s97, s64, 1
    s_add_u32 m0, s97, 32768
    s_add_u32 s98, s23, 2
    s_and_b32 s98, s98, 7
    s_lshl_b32 s97, s98, 16
    s_add_u32 s97, s97, s67
    s_mul_i32 s98, s98, 176128
    s_add_u32 s98, s98, s68
    s_waitcnt lgkmcnt(0)
    s_barrier
    v_mfma_f32_32x32x16_bf16 v[80:95], v[132:135], v[136:139], v[80:95]
    buffer_load_dwordx4 v26, s[40:43], s97 offen offset:0 sc1 lds
    v_mfma_f32_32x32x16_bf16 v[112:127], v[132:135], v[140:143], v[112:127]
    v_mfma_f32_32x32x16_bf16 v[64:79], v[144:147], v[152:155], v[64:79]
    buffer_load_dwordx4 v26, s[40:43], s97 offen offset:1024 sc1 lds
    v_mfma_f32_32x32x16_bf16 v[96:111], v[144:147], v[156:159], v[96:111]
    v_mfma_f32_32x32x16_bf16 v[80:95], v[148:151], v[152:155], v[80:95]
    buffer_load_dwordx4 v27, s[40:43], s97 offen offset:2048 sc1 lds
    v_mfma_f32_32x32x16_bf16 v[112:127], v[148:151], v[156:159], v[112:127]
    s_mov_b32 s10, 0x3fb8aa3b
    s_mov_b32 s11, s10
    s_mov_b32 s12, 0x358637bd
    v_mov_b32 v160, 0x3f803f80
    v_mov_b32 v161, 0x3f803f80
    v_mov_b32 v162, 0x3f803f80
    v_mov_b32 v163, 0x3f803f80
    s_nop 1
    v_cvt_pk_bf16_f32 v144, v96, v97
    v_cvt_pk_bf16_f32 v145, v98, v99
    buffer_load_dwordx4 v27, s[40:43], s97 offen offset:3072 sc1 lds
    v_cvt_pk_bf16_f32 v146, v100, v101
    v_cvt_pk_bf16_f32 v147, v102, v103
    v_cvt_pk_bf16_f32 v148, v104, v105
    v_cvt_pk_bf16_f32 v149, v106, v107
    v_cvt_pk_bf16_f32 v150, v108, v109
    v_cvt_pk_bf16_f32 v151, v110, v111
    s_add_u32 m0, s64, 49152
    s_nop 0
    buffer_load_dwordx4 v28, s[56:59], s98 offen offset:0 lds
    v_cvt_pk_bf16_f32 v152, v112, v113
    v_cvt_pk_bf16_f32 v153, v114, v115
    v_cvt_pk_bf16_f32 v154, v116, v117
    v_cvt_pk_bf16_f32 v155, v118, v119
    v_cvt_pk_bf16_f32 v156, v120, v121
    v_cvt_pk_bf16_f32 v157, v122, v123
    s_add_u32 m0, s64, 57216
    s_nop 0
    buffer_load_dwordx4 v28, s[56:59], s98 offen offset:128 lds
    v_cvt_pk_bf16_f32 v158, v124, v125
    v_cvt_pk_bf16_f32 v159, v126, v127
    v_pk_mul_f32 v[176:177], v[64:65], s[10:11]
    v_pk_mul_f32 v[178:179], v[66:67], s[10:11]
    v_pk_mul_f32 v[180:181], v[68:69], s[10:11]
    v_pk_mul_f32 v[182:183], v[70:71], s[10:11]
    s_add_u32 m0, s64, 49152
    s_nop 0
    buffer_load_dwordx4 v29, s[56:59], s98 offen offset:1024 lds
    v_pk_mul_f32 v[184:185], v[72:73], s[10:11]
    v_pk_mul_f32 v[186:187], v[74:75], s[10:11]
    v_pk_mul_f32 v[188:189], v[76:77], s[10:11]
    v_pk_mul_f32 v[190:191], v[78:79], s[10:11]
    v_exp_f32_e64 v176, v176 clamp
    s_add_u32 m0, s64, 57216
    s_nop 0
    buffer_load_dwordx4 v29, s[56:59], s98 offen offset:1152 lds
    v_max_f32 v64, s12, v64
    v_exp_f32_e64 v177, v177 clamp
    v_max_f32 v65, s12, v65
    v_exp_f32_e64 v178, v178 clamp
    v_max_f32 v66, s12, v66
    v_exp_f32_e64 v179, v179 clamp
    v_max_f32 v67, s12, v67
    v_exp_f32_e64 v180, v180 clamp
    v_max_f32 v68, s12, v68
    v_exp_f32_e64 v181, v181 clamp
    v_max_f32 v69, s12, v69
    v_exp_f32_e64 v182, v182 clamp
    v_max_f32 v70, s12, v70
    v_exp_f32_e64 v183, v183 clamp
    v_max_f32 v71, s12, v71
    v_exp_f32_e64 v184, v184 clamp
    v_max_f32 v72, s12, v72
    v_exp_f32_e64 v185, v185 clamp
    v_max_f32 v73, s12, v73
    v_exp_f32_e64 v186, v186 clamp
    v_max_f32 v74, s12, v74
    v_exp_f32_e64 v187, v187 clamp
    v_max_f32 v75, s12, v75
    v_exp_f32_e64 v188, v188 clamp
    v_max_f32 v76, s12, v76
    v_exp_f32_e64 v189, v189 clamp
    v_max_f32 v77, s12, v77
    v_exp_f32_e64 v190, v190 clamp
    v_max_f32 v78, s12, v78
    v_exp_f32_e64 v191, v191 clamp
    v_max_f32 v79, s12, v79
    v_pk_add_f32 v[64:65], v[64:65], v[176:177]
    v_pk_add_f32 v[66:67], v[66:67], v[178:179]
    v_pk_add_f32 v[68:69], v[68:69], v[180:181]
    v_pk_add_f32 v[70:71], v[70:71], v[182:183]
    v_pk_add_f32 v[72:73], v[72:73], v[184:185]
    v_pk_add_f32 v[74:75], v[74:75], v[186:187]
    v_pk_add_f32 v[76:77], v[76:77], v[188:189]
    v_pk_add_f32 v[78:79], v[78:79], v[190:191]
    v_cvt_pk_bf16_f32 v128, v64, v65
    v_cvt_pk_bf16_f32 v129, v66, v67
    v_cvt_pk_bf16_f32 v130, v68, v69
    v_cvt_pk_bf16_f32 v131, v70, v71
    v_cvt_pk_bf16_f32 v132, v72, v73
    v_cvt_pk_bf16_f32 v133, v74, v75
    v_cvt_pk_bf16_f32 v134, v76, v77
    v_cvt_pk_bf16_f32 v135, v78, v79
    v_mfma_f32_32x32x16_bf16 v[208:223], v[128:131], v[144:147], 0
    v_mfma_f32_32x32x16_bf16 v[224:239], v[160:163], v[128:131], 0
    v_mfma_f32_32x32x16_bf16 v[208:223], v[132:135], v[148:151], v[208:223]
    v_mfma_f32_32x32x16_bf16 v[224:239], v[160:163], v[132:135], v[224:239]
    v_pk_mul_f32 v[176:177], v[80:81], s[10:11]
    v_pk_mul_f32 v[178:179], v[82:83], s[10:11]
    v_pk_mul_f32 v[180:181], v[84:85], s[10:11]
    v_pk_mul_f32 v[182:183], v[86:87], s[10:11]
    v_pk_mul_f32 v[184:185], v[88:89], s[10:11]
    v_pk_mul_f32 v[186:187], v[90:91], s[10:11]
    v_pk_mul_f32 v[188:189], v[92:93], s[10:11]
    v_pk_mul_f32 v[190:191], v[94:95], s[10:11]
    v_exp_f32_e64 v176, v176 clamp
    v_max_f32 v80, s12, v80
    v_exp_f32_e64 v177, v177 clamp
    v_max_f32 v81, s12, v81
    v_exp_f32_e64 v178, v178 clamp
    v_max_f32 v82, s12, v82
    v_exp_f32_e64 v179, v179 clamp
    v_max_f32 v83, s12, v83
    v_exp_f32_e64 v180, v180 clamp
    v_max_f32 v84, s12, v84
    v_exp_f32_e64 v181, v181 clamp
    v_max_f32 v85, s12, v85
    v_exp_f32_e64 v182, v182 clamp
    v_max_f32 v86, s12, v86
    v_exp_f32_e64 v183, v183 clamp
    v_max_f32 v87, s12, v87
    v_exp_f32_e64 v184, v184 clamp
    v_max_f32 v88, s12, v88
    v_exp_f32_e64 v185, v185 clamp
    v_max_f32 v89, s12, v89
    v_exp_f32_e64 v186, v186 clamp
    v_max_f32 v90, s12, v90
    v_exp_f32_e64 v187, v187 clamp
    v_max_f32 v91, s12, v91
    v_exp_f32_e64 v188, v188 clamp
    v_max_f32 v92, s12, v92
    v_exp_f32_e64 v189, v189 clamp
    v_max_f32 v93, s12, v93
    v_exp_f32_e64 v190, v190 clamp
    v_max_f32 v94, s12, v94
    v_exp_f32_e64 v191, v191 clamp
    v_max_f32 v95, s12, v95
    v_pk_add_f32 v[80:81], v[80:81], v[176:177]
    v_pk_add_f32 v[82:83], v[82:83], v[178:179]
    v_pk_add_f32 v[84:85], v[84:85], v[180:181]
    v_pk_add_f32 v[86:87], v[86:87], v[182:183]
    v_pk_add_f32 v[88:89], v[88:89], v[184:185]
    v_pk_add_f32 v[90:91], v[90:91], v[186:187]
    v_pk_add_f32 v[92:93], v[92:93], v[188:189]
    v_pk_add_f32 v[94:95], v[94:95], v[190:191]
    v_cvt_pk_bf16_f32 v136, v80, v81
    v_cvt_pk_bf16_f32 v137, v82, v83
    v_cvt_pk_bf16_f32 v138, v84, v85
    v_cvt_pk_bf16_f32 v139, v86, v87
    v_cvt_pk_bf16_f32 v140, v88, v89
    v_cvt_pk_bf16_f32 v141, v90, v91
    v_cvt_pk_bf16_f32 v142, v92, v93
    v_cvt_pk_bf16_f32 v143, v94, v95
    v_mfma_f32_32x32x16_bf16 v[208:223], v[136:139], v[152:155], v[208:223]
    v_mfma_f32_32x32x16_bf16 v[224:239], v[160:163], v[136:139], v[224:239]
    v_mfma_f32_32x32x16_bf16 v[208:223], v[140:143], v[156:159], v[208:223]
    v_mfma_f32_32x32x16_bf16 v[224:239], v[160:163], v[140:143], v[224:239]
    v_and_b32 v6, 16, v1
    v_lshlrev_b32 v7, 4, v1
    s_lshr_b32 s13, s3, 1
    s_lshl_b32 s12, s13, 12
    s_add_u32 s12, s12, 98304
    v_add_u32 v5, s12, v7
    v_cmp_eq_u32 vcc, 0, v6
    s_lshl_b32 s12, s70, 1
    s_add_u32 s12, s12, s13
    s_lshl_b32 s12, s12, 4
    s_add_u32 s12, s12, s7
    s_mul_i32 s12, s12, 3072
    s_add_u32 s12, s12, 8388608
    v_mov_b32 v167, s96
    v_mov_b32 v171, s96
    v_mov_b32 v175, s96
    v_cndmask_b32 v164, v216, v208, vcc
    v_cndmask_b32 v165, v217, v209, vcc
    v_cndmask_b32 v166, v218, v210, vcc
    v_cndmask_b32 v168, v219, v211, vcc
    v_cndmask_b32 v169, v220, v212, vcc
    v_cndmask_b32 v170, v221, v213, vcc
    v_cndmask_b32 v172, v222, v214, vcc
    v_cndmask_b32 v173, v223, v215, vcc
    v_mov_b32 v174, v224
    s_bitcmp1_b32 s3, 0
    s_cbranch_scc0 L_kvr0
    ds_write_b128 v5, v[164:167] offset:0
    ds_write_b128 v5, v[168:171] offset:1024
    ds_write_b128 v5, v[172:175] offset:2048
L_kvr0:
    s_waitcnt lgkmcnt(0)
    s_barrier
    s_bitcmp1_b32 s3, 0
    s_cbranch_scc1 L_kvr1
    ds_read_b128 v[208:211], v5 offset:0
    ds_read_b128 v[212:215], v5 offset:1024
    ds_read_b128 v[216:219], v5 offset:2048
    s_waitcnt lgkmcnt(0)
    v_pk_add_f32 v[164:165], v[164:165], v[208:209]
    v_add_f32 v166, v166, v210
    v_pk_add_f32 v[168:169], v[168:169], v[212:213]
    v_add_f32 v170, v170, v214
    v_pk_add_f32 v[172:173], v[172:173], v[216:217]
    v_add_f32 v174, v174, v218
    buffer_store_dwordx4 v[164:167], v7, s[40:43], s12 offen offset:0 sc1
    buffer_store_dwordx4 v[168:171], v7, s[40:43], s12 offen offset:1024 sc1
    buffer_store_dwordx4 v[172:175], v7, s[40:43], s12 offen offset:2048 sc1
L_kvr1:
    s_waitcnt vmcnt(16)
    s_barrier
    ds_read_b128 v[128:131], v34 offset:0
    ds_read_b128 v[132:135], v35 offset:0
    ds_read_b64_tr_b16 v[136:137], v38 offset:16384
    ds_read_b64_tr_b16 v[138:139], v38 offset:16896
    ds_read_b64_tr_b16 v[140:141], v39 offset:16384
    ds_read_b64_tr_b16 v[142:143], v39 offset:16896
    ds_read_b128 v[144:147], v34 offset:4096
    ds_read_b128 v[148:151], v35 offset:4096
    ds_read_b64_tr_b16 v[152:153], v38 offset:18432
    ds_read_b64_tr_b16 v[154:155], v38 offset:18944
    ds_read_b64_tr_b16 v[156:157], v39 offset:18432
    ds_read_b64_tr_b16 v[158:159], v39 offset:18944
    s_waitcnt lgkmcnt(6)
    v_mfma_f32_32x32x16_bf16 v[240:255], v[136:139], v[128:131], v[240:255]
    ds_read_b128 v[160:163], v34 offset:8192
    s_mov_b32 s52, s20
    s_mov_b32 s53, s21
    ds_read_b128 v[164:167], v35 offset:8192
    v_mfma_f32_32x32x16_bf16 v[96:111], v[140:143], v[128:131], 0
    s_mov_b32 s54, 524288
    s_mov_b32 s55, 0x20000
    ds_read_b64_tr_b16 v[168:169], v38 offset:20480
    s_mov_b32 s48, s28
    s_mov_b32 s49, s29
    v_mfma_f32_32x32x16_bf16 v[80:95], v[136:139], v[132:135], 0
    ds_read_b64_tr_b16 v[170:171], v38 offset:20992
    s_mov_b32 s50, 5636096
    s_mov_b32 s51, 0x20000
    ds_read_b64_tr_b16 v[172:173], v39 offset:20480
    v_mfma_f32_32x32x16_bf16 v[112:127], v[140:143], v[132:135], 0
    v_accvgpr_read_b32 v8, a200
    ds_read_b64_tr_b16 v[174:175], v39 offset:20992
    v_accvgpr_read_b32 v9, a201
    s_waitcnt lgkmcnt(6)
    v_mfma_f32_32x32x16_bf16 v[240:255], v[152:155], v[144:147], v[240:255]
    ds_read_b128 v[128:131], v34 offset:12288
    v_accvgpr_read_b32 v10, a202
    ds_read_b128 v[132:135], v35 offset:12288
    v_mfma_f32_32x32x16_bf16 v[96:111], v[156:159], v[144:147], v[96:111]
    v_accvgpr_read_b32 v11, a203
    ds_read_b64_tr_b16 v[136:137], v38 offset:22528
    v_accvgpr_read_b32 v12, a204
    v_mfma_f32_32x32x16_bf16 v[80:95], v[152:155], v[148:151], v[80:95]
    ds_read_b64_tr_b16 v[138:139], v38 offset:23040
    v_accvgpr_read_b32 v13, a205
    ds_read_b64_tr_b16 v[140:141], v39 offset:22528
    v_mfma_f32_32x32x16_bf16 v[112:127], v[156:159], v[148:151], v[112:127]
    v_accvgpr_read_b32 v14, a206
    ds_read_b64_tr_b16 v[142:143], v39 offset:23040
    v_accvgpr_read_b32 v15, a207
    s_waitcnt lgkmcnt(6)
    v_mfma_f32_32x32x16_bf16 v[240:255], v[168:171], v[160:163], v[240:255]
    v_mfma_f32_32x32x16_bf16 v[96:111], v[172:175], v[160:163], v[96:111]
    s_lshl_b32 s97, s64, 1
    s_add_u32 m0, s97, 65536
    s_add_u32 s98, s23, 3
    s_and_b32 s98, s98, 7
    s_lshl_b32 s97, s98, 16
    s_add_u32 s97, s97, s67
    s_mul_i32 s98, s98, 176128
    s_add_u32 s98, s98, s68
    s_waitcnt vmcnt(8) lgkmcnt(0)
    s_barrier
    v_mfma_f32_32x32x16_bf16 v[80:95], v[168:171], v[164:167], v[80:95]
    ds_read_b128 v[144:147], v32 offset:0
    ds_read_b128 v[148:151], v33 offset:0
    ds_read_b64_tr_b16 v[152:153], v36 offset:16384
    ds_read_b64_tr_b16 v[154:155], v36 offset:16896
    v_mfma_f32_32x32x16_bf16 v[112:127], v[172:175], v[164:167], v[112:127]
    ds_read_b64_tr_b16 v[156:157], v37 offset:16384
    ds_read_b64_tr_b16 v[158:159], v37 offset:16896
    buffer_load_dwordx4 v26, s[40:43], s97 offen offset:0 sc1 lds
    v_mfma_f32_32x32x16_bf16 v[240:255], v[136:139], v[128:131], v[240:255]
    ds_read_b128 v[160:163], v32 offset:4096
    ds_read_b128 v[164:167], v33 offset:4096
    buffer_load_dwordx4 v26, s[40:43], s97 offen offset:1024 sc1 lds
    v_mfma_f32_32x32x16_bf16 v[96:111], v[140:143], v[128:131], v[96:111]
    ds_read_b64_tr_b16 v[168:169], v36 offset:18432
    buffer_load_dwordx4 v27, s[40:43], s97 offen offset:2048 sc1 lds
    ds_read_b64_tr_b16 v[170:171], v36 offset:18944
    v_mfma_f32_32x32x16_bf16 v[80:95], v[136:139], v[132:135], v[80:95]
    v_accvgpr_read_b32 v16, a208
    ds_read_b64_tr_b16 v[172:173], v37 offset:18432
    v_accvgpr_read_b32 v17, a209
    v_mfma_f32_32x32x16_bf16 v[112:127], v[140:143], v[132:135], v[112:127]
    ds_read_b64_tr_b16 v[174:175], v37 offset:18944
    v_accvgpr_read_b32 v18, a210
    s_waitcnt lgkmcnt(6)
    v_mfma_f32_32x32x16_bf16 v[240:255], v[152:155], v[144:147], v[240:255]
    ds_read_b128 v[128:131], v32 offset:8192
    ds_read_b128 v[132:135], v33 offset:8192
    buffer_load_dwordx4 v27, s[40:43], s97 offen offset:3072 sc1 lds
    v_mfma_f32_32x32x16_bf16 v[96:111], v[156:159], v[144:147], v[96:111]
    ds_read_b64_tr_b16 v[136:137], v36 offset:20480
    s_add_u32 m0, s64, 81920
    s_nop 0
    buffer_load_dwordx4 v28, s[56:59], s98 offen offset:0 lds
    ds_read_b64_tr_b16 v[138:139], v36 offset:20992
    v_mfma_f32_32x32x16_bf16 v[80:95], v[152:155], v[148:151], v[80:95]
    v_accvgpr_read_b32 v19, a211
    ds_read_b64_tr_b16 v[140:141], v37 offset:20480
    v_accvgpr_read_b32 v20, a212
    v_mfma_f32_32x32x16_bf16 v[112:127], v[156:159], v[148:151], v[112:127]
    ds_read_b64_tr_b16 v[142:143], v37 offset:20992
    v_accvgpr_read_b32 v21, a213
    s_waitcnt lgkmcnt(6)
    v_mfma_f32_32x32x16_bf16 v[240:255], v[168:171], v[160:163], v[240:255]
    ds_read_b128 v[144:147], v32 offset:12288
    ds_read_b128 v[148:151], v33 offset:12288
    s_add_u32 m0, s64, 89984
    s_nop 0
    buffer_load_dwordx4 v28, s[56:59], s98 offen offset:128 lds
    v_mfma_f32_32x32x16_bf16 v[96:111], v[172:175], v[160:163], v[96:111]
    ds_read_b64_tr_b16 v[152:153], v36 offset:22528
    s_add_u32 m0, s64, 81920
    s_nop 0
    buffer_load_dwordx4 v29, s[56:59], s98 offen offset:1024 lds
    ds_read_b64_tr_b16 v[154:155], v36 offset:23040
    v_mfma_f32_32x32x16_bf16 v[80:95], v[168:171], v[164:167], v[80:95]
    v_accvgpr_read_b32 v22, a214
    ds_read_b64_tr_b16 v[156:157], v37 offset:22528
    v_accvgpr_read_b32 v23, a215
    v_mfma_f32_32x32x16_bf16 v[112:127], v[172:175], v[164:167], v[112:127]
    ds_read_b64_tr_b16 v[158:159], v37 offset:23040
    v_accvgpr_read_b32 v24, a216
    s_waitcnt lgkmcnt(6)
    v_mfma_f32_32x32x16_bf16 v[240:255], v[136:139], v[128:131], v[240:255]
    s_add_u32 m0, s64, 89984
    s_nop 0
    buffer_load_dwordx4 v29, s[56:59], s98 offen offset:1152 lds
    v_mfma_f32_32x32x16_bf16 v[96:111], v[140:143], v[128:131], v[96:111]
    s_lshl_b32 s97, s64, 1
    s_add_u32 m0, s97, 0
    s_add_u32 s98, s23, 4
    s_and_b32 s98, s98, 7
    s_lshl_b32 s97, s98, 16
    s_add_u32 s97, s97, s67
    s_mul_i32 s98, s98, 176128
    s_add_u32 s98, s98, s68
    s_waitcnt vmcnt(8) lgkmcnt(0)
    s_barrier
    v_mfma_f32_32x32x16_bf16 v[80:95], v[136:139], v[132:135], v[80:95]
    ds_read_b128 v[160:163], v32 offset:32768
    ds_read_b128 v[164:167], v33 offset:32768
    ds_read_b64_tr_b16 v[168:169], v36 offset:49152
    ds_read_b64_tr_b16 v[170:171], v36 offset:49664
    v_mfma_f32_32x32x16_bf16 v[112:127], v[140:143], v[132:135], v[112:127]
    ds_read_b64_tr_b16 v[172:173], v37 offset:49152
    ds_read_b64_tr_b16 v[174:175], v37 offset:49664
    buffer_load_dwordx4 v26, s[40:43], s97 offen offset:0 sc1 lds
    v_mfma_f32_32x32x16_bf16 v[240:255], v[152:155], v[144:147], v[240:255]
    ds_read_b128 v[128:131], v32 offset:36864
    ds_read_b128 v[132:135], v33 offset:36864
    buffer_load_dwordx4 v26, s[40:43], s97 offen offset:1024 sc1 lds
    v_mfma_f32_32x32x16_bf16 v[96:111], v[156:159], v[144:147], v[96:111]
    ds_read_b64_tr_b16 v[136:137], v36 offset:51200
    buffer_load_dwordx4 v27, s[40:43], s97 offen offset:2048 sc1 lds
    v_mfma_f32_32x32x16_bf16 v[80:95], v[152:155], v[148:151], v[80:95]
    ds_read_b64_tr_b16 v[138:139], v36 offset:51712
    ds_read_b64_tr_b16 v[140:141], v37 offset:51200
    v_accvgpr_read_b32 v25, a217
    v_mfma_f32_32x32x16_bf16 v[112:127], v[156:159], v[148:151], v[112:127]
    ds_read_b64_tr_b16 v[142:143], v37 offset:51712
    s_mov_b32 s60, s30
    s_mov_b32 s61, s31
    s_mov_b32 s62, 4096
    s_mov_b32 s63, 0x20000
    s_lshl_b32 s14, s16, 7
    v_and_b32 v2, 31, v1
    v_lshlrev_b32 v2, 1, v2
    buffer_load_ushort v46, v2, s[60:63], s14 offen
    buffer_load_ushort v47, v2, s[60:63], s14 offen offset:64
    buffer_load_dwordx2 v[56:57], v22, s[40:43], 0 offen sc1
    buffer_load_dwordx2 v[58:59], v23, s[40:43], 0 offen sc1
    s_waitcnt lgkmcnt(6)
    v_mfma_f32_32x32x16_bf16 v[240:255], v[168:171], v[160:163], v[240:255]
    ds_read_b128 v[144:147], v32 offset:40960
    ds_read_b128 v[148:151], v33 offset:40960
    v_mfma_f32_32x32x16_bf16 v[96:111], v[172:175], v[160:163], v[96:111]
    ds_read_b64_tr_b16 v[152:153], v36 offset:53248
    buffer_load_dwordx4 v27, s[40:43], s97 offen offset:3072 sc1 lds
    v_mfma_f32_32x32x16_bf16 v[80:95], v[168:171], v[164:167], v[80:95]
    ds_read_b64_tr_b16 v[154:155], v36 offset:53760
    ds_read_b64_tr_b16 v[156:157], v37 offset:53248
    v_mfma_f32_32x32x16_bf16 v[112:127], v[172:175], v[164:167], v[112:127]
    ds_read_b64_tr_b16 v[158:159], v37 offset:53760
    s_add_u32 m0, s64, 16384
    s_nop 0
    buffer_load_dwordx4 v28, s[56:59], s98 offen offset:0 lds
    s_waitcnt lgkmcnt(6)
    v_mfma_f32_32x32x16_bf16 v[240:255], v[136:139], v[128:131], v[240:255]
    ds_read_b128 v[160:163], v32 offset:45056
    ds_read_b128 v[164:167], v33 offset:45056
    v_mfma_f32_32x32x16_bf16 v[96:111], v[140:143], v[128:131], v[96:111]
    ds_read_b64_tr_b16 v[168:169], v36 offset:55296
    s_add_u32 m0, s64, 24448
    s_nop 0
    buffer_load_dwordx4 v28, s[56:59], s98 offen offset:128 lds
    v_mfma_f32_32x32x16_bf16 v[80:95], v[136:139], v[132:135], v[80:95]
    ds_read_b64_tr_b16 v[170:171], v36 offset:55808
    ds_read_b64_tr_b16 v[172:173], v37 offset:55296
    v_mfma_f32_32x32x16_bf16 v[112:127], v[140:143], v[132:135], v[112:127]
    ds_read_b64_tr_b16 v[174:175], v37 offset:55808
    s_add_u32 m0, s64, 16384
    s_nop 0
    buffer_load_dwordx4 v29, s[56:59], s98 offen offset:1024 lds
    s_waitcnt lgkmcnt(6)
    v_mfma_f32_32x32x16_bf16 v[240:255], v[152:155], v[144:147], v[240:255]
    s_add_u32 m0, s64, 24448
    s_nop 0
    buffer_load_dwordx4 v29, s[56:59], s98 offen offset:1152 lds
    v_mfma_f32_32x32x16_bf16 v[96:111], v[156:159], v[144:147], v[96:111]
    s_lshl_b32 s97, s64, 1
    s_add_u32 m0, s97, 32768
    s_add_u32 s98, s23, 5
    s_and_b32 s98, s98, 7
    s_lshl_b32 s97, s98, 16
    s_add_u32 s97, s97, s67
    s_mul_i32 s98, s98, 176128
    s_add_u32 s98, s98, s68
    s_waitcnt vmcnt(12) lgkmcnt(0)
    s_barrier
    v_mfma_f32_32x32x16_bf16 v[80:95], v[152:155], v[148:151], v[80:95]
    ds_read_b128 v[128:131], v34 offset:0
    ds_read_b128 v[132:135], v35 offset:0
    ds_read_b64_tr_b16 v[136:137], v38 offset:16384
    ds_read_b64_tr_b16 v[138:139], v38 offset:16896
    v_mfma_f32_32x32x16_bf16 v[112:127], v[156:159], v[148:151], v[112:127]
    ds_read_b64_tr_b16 v[140:141], v39 offset:16384
    ds_read_b64_tr_b16 v[142:143], v39 offset:16896
    buffer_load_dwordx4 v26, s[40:43], s97 offen offset:0 sc1 lds
    v_mfma_f32_32x32x16_bf16 v[240:255], v[168:171], v[160:163], v[240:255]
    ds_read_b128 v[144:147], v34 offset:4096
    ds_read_b128 v[148:151], v35 offset:4096
    v_mfma_f32_32x32x16_bf16 v[96:111], v[172:175], v[160:163], v[96:111]
    ds_read_b64_tr_b16 v[152:153], v38 offset:18432
    buffer_load_dwordx4 v26, s[40:43], s97 offen offset:1024 sc1 lds
    v_mfma_f32_32x32x16_bf16 v[80:95], v[168:171], v[164:167], v[80:95]
    ds_read_b64_tr_b16 v[154:155], v38 offset:18944
    ds_read_b64_tr_b16 v[156:157], v39 offset:18432
    v_mfma_f32_32x32x16_bf16 v[112:127], v[172:175], v[164:167], v[112:127]
    ds_read_b64_tr_b16 v[158:159], v39 offset:18944
    buffer_load_dwordx4 v27, s[40:43], s97 offen offset:2048 sc1 lds
    s_waitcnt lgkmcnt(6)
    v_mfma_f32_32x32x16_bf16 v[240:255], v[136:139], v[128:131], v[240:255]
    ds_read_b128 v[160:163], v34 offset:8192
    ds_read_b128 v[164:167], v35 offset:8192
    v_mfma_f32_32x32x16_bf16 v[96:111], v[140:143], v[128:131], v[96:111]
    ds_read_b64_tr_b16 v[168:169], v38 offset:20480
    buffer_load_dwordx4 v27, s[40:43], s97 offen offset:3072 sc1 lds
    v_mfma_f32_32x32x16_bf16 v[80:95], v[136:139], v[132:135], v[80:95]
    ds_read_b64_tr_b16 v[170:171], v38 offset:20992
    ds_read_b64_tr_b16 v[172:173], v39 offset:20480
    v_mfma_f32_32x32x16_bf16 v[112:127], v[140:143], v[132:135], v[112:127]
    ds_read_b64_tr_b16 v[174:175], v39 offset:20992
    s_add_u32 m0, s64, 49152
    s_nop 0
    buffer_load_dwordx4 v28, s[56:59], s98 offen offset:0 lds
    s_waitcnt lgkmcnt(6)
    v_mfma_f32_32x32x16_bf16 v[240:255], v[152:155], v[144:147], v[240:255]
    ds_read_b128 v[128:131], v34 offset:12288
    ds_read_b128 v[132:135], v35 offset:12288
    v_mfma_f32_32x32x16_bf16 v[96:111], v[156:159], v[144:147], v[96:111]
    ds_read_b64_tr_b16 v[136:137], v38 offset:22528
    s_add_u32 m0, s64, 57216
    s_nop 0
    buffer_load_dwordx4 v28, s[56:59], s98 offen offset:128 lds
    v_mfma_f32_32x32x16_bf16 v[80:95], v[152:155], v[148:151], v[80:95]
    ds_read_b64_tr_b16 v[138:139], v38 offset:23040
    ds_read_b64_tr_b16 v[140:141], v39 offset:22528
    v_mfma_f32_32x32x16_bf16 v[112:127], v[156:159], v[148:151], v[112:127]
    ds_read_b64_tr_b16 v[142:143], v39 offset:23040
    s_add_u32 m0, s64, 49152
    s_nop 0
    buffer_load_dwordx4 v29, s[56:59], s98 offen offset:1024 lds
    s_waitcnt lgkmcnt(6)
    v_mfma_f32_32x32x16_bf16 v[240:255], v[168:171], v[160:163], v[240:255]
    s_add_u32 m0, s64, 57216
    s_nop 0
    buffer_load_dwordx4 v29, s[56:59], s98 offen offset:1152 lds
    v_mfma_f32_32x32x16_bf16 v[96:111], v[172:175], v[160:163], v[96:111]
    s_lshl_b32 s97, s64, 1
    s_add_u32 m0, s97, 65536
    s_add_u32 s98, s23, 6
    s_and_b32 s98, s98, 7
    s_lshl_b32 s97, s98, 16
    s_add_u32 s97, s97, s67
    s_mul_i32 s98, s98, 176128
    s_add_u32 s98, s98, s68
    s_waitcnt vmcnt(8) lgkmcnt(0)
    s_barrier
    v_mfma_f32_32x32x16_bf16 v[80:95], v[168:171], v[164:167], v[80:95]
    ds_read_b128 v[144:147], v32 offset:0
    ds_read_b128 v[148:151], v33 offset:0
    ds_read_b64_tr_b16 v[152:153], v36 offset:16384
    ds_read_b64_tr_b16 v[154:155], v36 offset:16896
    v_mfma_f32_32x32x16_bf16 v[112:127], v[172:175], v[164:167], v[112:127]
    ds_read_b64_tr_b16 v[156:157], v37 offset:16384
    ds_read_b64_tr_b16 v[158:159], v37 offset:16896
    buffer_load_dwordx4 v26, s[40:43], s97 offen offset:0 sc1 lds
    v_mfma_f32_32x32x16_bf16 v[240:255], v[136:139], v[128:131], v[240:255]
    ds_read_b128 v[160:163], v32 offset:4096
    ds_read_b128 v[164:167], v33 offset:4096
    v_mfma_f32_32x32x16_bf16 v[96:111], v[140:143], v[128:131], v[96:111]
    ds_read_b64_tr_b16 v[168:169], v36 offset:18432
    buffer_load_dwordx4 v26, s[40:43], s97 offen offset:1024 sc1 lds
    v_mfma_f32_32x32x16_bf16 v[80:95], v[136:139], v[132:135], v[80:95]
    ds_read_b64_tr_b16 v[170:171], v36 offset:18944
    ds_read_b64_tr_b16 v[172:173], v37 offset:18432
    v_mfma_f32_32x32x16_bf16 v[112:127], v[140:143], v[132:135], v[112:127]
    ds_read_b64_tr_b16 v[174:175], v37 offset:18944
    buffer_load_dwordx4 v27, s[40:43], s97 offen offset:2048 sc1 lds
    s_waitcnt lgkmcnt(6)
    v_mfma_f32_32x32x16_bf16 v[240:255], v[152:155], v[144:147], v[240:255]
    ds_read_b128 v[128:131], v32 offset:8192
    ds_read_b128 v[132:135], v33 offset:8192
    v_mfma_f32_32x32x16_bf16 v[96:111], v[156:159], v[144:147], v[96:111]
    ds_read_b64_tr_b16 v[136:137], v36 offset:20480
    buffer_load_dwordx4 v27, s[40:43], s97 offen offset:3072 sc1 lds
    v_mfma_f32_32x32x16_bf16 v[80:95], v[152:155], v[148:151], v[80:95]
    ds_read_b64_tr_b16 v[138:139], v36 offset:20992
    ds_read_b64_tr_b16 v[140:141], v37 offset:20480
    v_mfma_f32_32x32x16_bf16 v[112:127], v[156:159], v[148:151], v[112:127]
    ds_read_b64_tr_b16 v[142:143], v37 offset:20992
    s_add_u32 m0, s64, 81920
    s_nop 0
    buffer_load_dwordx4 v28, s[56:59], s98 offen offset:0 lds
    s_waitcnt lgkmcnt(6)
    v_mfma_f32_32x32x16_bf16 v[240:255], v[168:171], v[160:163], v[240:255]
    ds_read_b128 v[144:147], v32 offset:12288
    ds_read_b128 v[148:151], v33 offset:12288
    v_mfma_f32_32x32x16_bf16 v[96:111], v[172:175], v[160:163], v[96:111]
    ds_read_b64_tr_b16 v[152:153], v36 offset:22528
    s_add_u32 m0, s64, 89984
    s_nop 0
    buffer_load_dwordx4 v28, s[56:59], s98 offen offset:128 lds
    v_mfma_f32_32x32x16_bf16 v[80:95], v[168:171], v[164:167], v[80:95]
    ds_read_b64_tr_b16 v[154:155], v36 offset:23040
    ds_read_b64_tr_b16 v[156:157], v37 offset:22528
    v_mfma_f32_32x32x16_bf16 v[112:127], v[172:175], v[164:167], v[112:127]
    ds_read_b64_tr_b16 v[158:159], v37 offset:23040
    s_add_u32 m0, s64, 81920
    s_nop 0
    buffer_load_dwordx4 v29, s[56:59], s98 offen offset:1024 lds
    s_waitcnt lgkmcnt(6)
    v_mfma_f32_32x32x16_bf16 v[240:255], v[136:139], v[128:131], v[240:255]
    s_add_u32 m0, s64, 89984
    s_nop 0
    buffer_load_dwordx4 v29, s[56:59], s98 offen offset:1152 lds
    v_mfma_f32_32x32x16_bf16 v[96:111], v[140:143], v[128:131], v[96:111]
    s_lshl_b32 s97, s64, 1
    s_add_u32 m0, s97, 0
    s_add_u32 s98, s23, 7
    s_and_b32 s98, s98, 7
    s_lshl_b32 s97, s98, 16
    s_add_u32 s97, s97, s67
    s_mul_i32 s98, s98, 176128
    s_add_u32 s98, s98, s68
    s_waitcnt vmcnt(8) lgkmcnt(0)
    s_barrier
    v_mfma_f32_32x32x16_bf16 v[80:95], v[136:139], v[132:135], v[80:95]
    ds_read_b128 v[160:163], v32 offset:32768
    ds_read_b128 v[164:167], v33 offset:32768
    ds_read_b64_tr_b16 v[168:169], v36 offset:49152
    ds_read_b64_tr_b16 v[170:171], v36 offset:49664
    v_mfma_f32_32x32x16_bf16 v[112:127], v[140:143], v[132:135], v[112:127]
    ds_read_b64_tr_b16 v[172:173], v37 offset:49152
    ds_read_b64_tr_b16 v[174:175], v37 offset:49664
    buffer_load_dwordx4 v26, s[40:43], s97 offen offset:0 sc1 lds
    v_mfma_f32_32x32x16_bf16 v[240:255], v[152:155], v[144:147], v[240:255]
    ds_read_b128 v[128:131], v32 offset:36864
    ds_read_b128 v[132:135], v33 offset:36864
    v_mfma_f32_32x32x16_bf16 v[96:111], v[156:159], v[144:147], v[96:111]
    ds_read_b64_tr_b16 v[136:137], v36 offset:51200
    buffer_load_dwordx4 v26, s[40:43], s97 offen offset:1024 sc1 lds
    v_mfma_f32_32x32x16_bf16 v[80:95], v[152:155], v[148:151], v[80:95]
    ds_read_b64_tr_b16 v[138:139], v36 offset:51712
    ds_read_b64_tr_b16 v[140:141], v37 offset:51200
    v_mfma_f32_32x32x16_bf16 v[112:127], v[156:159], v[148:151], v[112:127]
    ds_read_b64_tr_b16 v[142:143], v37 offset:51712
    buffer_load_dwordx4 v27, s[40:43], s97 offen offset:2048 sc1 lds
    s_waitcnt lgkmcnt(6)
    v_mfma_f32_32x32x16_bf16 v[240:255], v[168:171], v[160:163], v[240:255]
    ds_read_b128 v[144:147], v32 offset:40960
    ds_read_b128 v[148:151], v33 offset:40960
    v_mfma_f32_32x32x16_bf16 v[96:111], v[172:175], v[160:163], v[96:111]
    ds_read_b64_tr_b16 v[152:153], v36 offset:53248
    buffer_load_dwordx4 v27, s[40:43], s97 offen offset:3072 sc1 lds
    v_mfma_f32_32x32x16_bf16 v[80:95], v[168:171], v[164:167], v[80:95]
    ds_read_b64_tr_b16 v[154:155], v36 offset:53760
    ds_read_b64_tr_b16 v[156:157], v37 offset:53248
    v_mfma_f32_32x32x16_bf16 v[112:127], v[172:175], v[164:167], v[112:127]
    ds_read_b64_tr_b16 v[158:159], v37 offset:53760
    s_add_u32 m0, s64, 16384
    s_nop 0
    buffer_load_dwordx4 v28, s[56:59], s98 offen offset:0 lds
    s_waitcnt lgkmcnt(6)
    v_mfma_f32_32x32x16_bf16 v[240:255], v[136:139], v[128:131], v[240:255]
    ds_read_b128 v[160:163], v32 offset:45056
    ds_read_b128 v[164:167], v33 offset:45056
    v_mfma_f32_32x32x16_bf16 v[96:111], v[140:143], v[128:131], v[96:111]
    ds_read_b64_tr_b16 v[168:169], v36 offset:55296
    s_add_u32 m0, s64, 24448
    s_nop 0
    buffer_load_dwordx4 v28, s[56:59], s98 offen offset:128 lds
    v_mfma_f32_32x32x16_bf16 v[80:95], v[136:139], v[132:135], v[80:95]
    ds_read_b64_tr_b16 v[170:171], v36 offset:55808
    ds_read_b64_tr_b16 v[172:173], v37 offset:55296
    v_mfma_f32_32x32x16_bf16 v[112:127], v[140:143], v[132:135], v[112:127]
    ds_read_b64_tr_b16 v[174:175], v37 offset:55808
    s_add_u32 m0, s64, 16384
    s_nop 0
    buffer_load_dwordx4 v29, s[56:59], s98 offen offset:1024 lds
    s_waitcnt lgkmcnt(6)
    v_mfma_f32_32x32x16_bf16 v[240:255], v[152:155], v[144:147], v[240:255]
    s_add_u32 m0, s64, 24448
    s_nop 0
    buffer_load_dwordx4 v29, s[56:59], s98 offen offset:1152 lds
    v_mfma_f32_32x32x16_bf16 v[96:111], v[156:159], v[144:147], v[96:111]
    s_waitcnt vmcnt(8) lgkmcnt(0)
    s_barrier
    v_mfma_f32_32x32x16_bf16 v[80:95], v[152:155], v[148:151], v[80:95]
    ds_read_b128 v[128:131], v34 offset:0
    ds_read_b128 v[132:135], v35 offset:0
    ds_read_b64_tr_b16 v[136:137], v38 offset:16384
    ds_read_b64_tr_b16 v[138:139], v38 offset:16896
    v_mfma_f32_32x32x16_bf16 v[112:127], v[156:159], v[148:151], v[112:127]
    ds_read_b64_tr_b16 v[140:141], v39 offset:16384
    ds_read_b64_tr_b16 v[142:143], v39 offset:16896
    s_lshl_b32 s12, s65, 2
    s_add_u32 s12, s12, s66
    s_lshl_b32 s12, s12, 8
    s_add_u32 s12, s12, 11567104
    v_and_b32 v30, 3, v1
    v_lshl_add_u32 v30, v30, 6, s12
    buffer_load_dword v31, v30, s[40:43], 0 offen sc1
    v_mfma_f32_32x32x16_bf16 v[240:255], v[168:171], v[160:163], v[240:255]
    ds_read_b128 v[144:147], v34 offset:4096
    ds_read_b128 v[148:151], v35 offset:4096
    v_mfma_f32_32x32x16_bf16 v[96:111], v[172:175], v[160:163], v[96:111]
    ds_read_b64_tr_b16 v[152:153], v38 offset:18432
    s_add_u32 m0, s64, 106496
    s_add_u32 s97, s33, 0
    buffer_load_dwordx4 v14, s[52:55], s97 offen lds
    v_mfma_f32_32x32x16_bf16 v[80:95], v[168:171], v[164:167], v[80:95]
    ds_read_b64_tr_b16 v[154:155], v38 offset:18944
    ds_read_b64_tr_b16 v[156:157], v39 offset:18432
    v_mfma_f32_32x32x16_bf16 v[112:127], v[172:175], v[164:167], v[112:127]
    ds_read_b64_tr_b16 v[158:159], v39 offset:18944
    buffer_load_dwordx4 v15, s[52:55], s97 offen offset:1024 lds
    s_waitcnt lgkmcnt(6)
    v_mfma_f32_32x32x16_bf16 v[240:255], v[136:139], v[128:131], v[240:255]
    ds_read_b128 v[160:163], v34 offset:8192
    ds_read_b128 v[164:167], v35 offset:8192
    v_mfma_f32_32x32x16_bf16 v[96:111], v[140:143], v[128:131], v[96:111]
    ds_read_b64_tr_b16 v[168:169], v38 offset:20480
    s_add_u32 m0, s64, 114688
    s_add_u32 s97, s33, 16384
    buffer_load_dwordx4 v14, s[52:55], s97 offen lds
    v_mfma_f32_32x32x16_bf16 v[80:95], v[136:139], v[132:135], v[80:95]
    ds_read_b64_tr_b16 v[170:171], v38 offset:20992
    ds_read_b64_tr_b16 v[172:173], v39 offset:20480
    v_mfma_f32_32x32x16_bf16 v[112:127], v[140:143], v[132:135], v[112:127]
    ds_read_b64_tr_b16 v[174:175], v39 offset:20992
    buffer_load_dwordx4 v15, s[52:55], s97 offen offset:1024 lds
    s_waitcnt lgkmcnt(6)
    v_mfma_f32_32x32x16_bf16 v[240:255], v[152:155], v[144:147], v[240:255]
    ds_read_b128 v[128:131], v34 offset:12288
    ds_read_b128 v[132:135], v35 offset:12288
    v_mfma_f32_32x32x16_bf16 v[96:111], v[156:159], v[144:147], v[96:111]
    ds_read_b64_tr_b16 v[136:137], v38 offset:22528
    s_add_u32 m0, s64, 122880
    s_add_u32 s97, s33, 32768
    buffer_load_dwordx4 v14, s[52:55], s97 offen lds
    v_mfma_f32_32x32x16_bf16 v[80:95], v[152:155], v[148:151], v[80:95]
    ds_read_b64_tr_b16 v[138:139], v38 offset:23040
    ds_read_b64_tr_b16 v[140:141], v39 offset:22528
    v_mfma_f32_32x32x16_bf16 v[112:127], v[156:159], v[148:151], v[112:127]
    ds_read_b64_tr_b16 v[142:143], v39 offset:23040
    buffer_load_dwordx4 v15, s[52:55], s97 offen offset:1024 lds
    s_waitcnt lgkmcnt(6)
    v_mfma_f32_32x32x16_bf16 v[240:255], v[168:171], v[160:163], v[240:255]
    s_add_u32 m0, s64, 131072
    s_add_u32 s97, s33, 49152
    buffer_load_dwordx4 v14, s[52:55], s97 offen lds
    v_mfma_f32_32x32x16_bf16 v[96:111], v[172:175], v[160:163], v[96:111]
    buffer_load_dwordx4 v15, s[52:55], s97 offen offset:1024 lds
    s_waitcnt vmcnt(9) lgkmcnt(0)
    s_barrier
    v_mfma_f32_32x32x16_bf16 v[80:95], v[168:171], v[164:167], v[80:95]
    ds_read_b128 v[144:147], v32 offset:0
    ds_read_b128 v[148:151], v33 offset:0
    ds_read_b64_tr_b16 v[152:153], v36 offset:16384
    ds_read_b64_tr_b16 v[154:155], v36 offset:16896
    v_mfma_f32_32x32x16_bf16 v[112:127], v[172:175], v[164:167], v[112:127]
    ds_read_b64_tr_b16 v[156:157], v37 offset:16384
    ds_read_b64_tr_b16 v[158:159], v37 offset:16896
    s_add_u32 m0, s64, 139264
    s_add_u32 s97, s33, 65536
    buffer_load_dwordx4 v14, s[52:55], s97 offen lds
    v_mfma_f32_32x32x16_bf16 v[240:255], v[136:139], v[128:131], v[240:255]
    ds_read_b128 v[160:163], v32 offset:4096
    ds_read_b128 v[164:167], v33 offset:4096
    v_mfma_f32_32x32x16_bf16 v[96:111], v[140:143], v[128:131], v[96:111]
    ds_read_b64_tr_b16 v[168:169], v36 offset:18432
    buffer_load_dwordx4 v15, s[52:55], s97 offen offset:1024 lds
    v_mfma_f32_32x32x16_bf16 v[80:95], v[136:139], v[132:135], v[80:95]
    ds_read_b64_tr_b16 v[170:171], v36 offset:18944
    ds_read_b64_tr_b16 v[172:173], v37 offset:18432
    v_mfma_f32_32x32x16_bf16 v[112:127], v[140:143], v[132:135], v[112:127]
    ds_read_b64_tr_b16 v[174:175], v37 offset:18944
    s_add_u32 m0, s64, 147456
    s_add_u32 s97, s33, 81920
    buffer_load_dwordx4 v14, s[52:55], s97 offen lds
    s_waitcnt lgkmcnt(6)
    v_mfma_f32_32x32x16_bf16 v[240:255], v[152:155], v[144:147], v[240:255]
    ds_read_b128 v[128:131], v32 offset:8192
    ds_read_b128 v[132:135], v33 offset:8192
    v_mfma_f32_32x32x16_bf16 v[96:111], v[156:159], v[144:147], v[96:111]
    ds_read_b64_tr_b16 v[136:137], v36 offset:20480
    buffer_load_dwordx4 v15, s[52:55], s97 offen offset:1024 lds
    v_mfma_f32_32x32x16_bf16 v[80:95], v[152:155], v[148:151], v[80:95]
    ds_read_b64_tr_b16 v[138:139], v36 offset:20992
    ds_read_b64_tr_b16 v[140:141], v37 offset:20480
    v_mfma_f32_32x32x16_bf16 v[112:127], v[156:159], v[148:151], v[112:127]
    ds_read_b64_tr_b16 v[142:143], v37 offset:20992
    s_add_u32 m0, s64, 155648
    s_add_u32 s97, s33, 98304
    buffer_load_dwordx4 v14, s[52:55], s97 offen lds
    s_waitcnt lgkmcnt(6)
    v_mfma_f32_32x32x16_bf16 v[240:255], v[168:171], v[160:163], v[240:255]
    ds_read_b128 v[144:147], v32 offset:12288
    ds_read_b128 v[148:151], v33 offset:12288
    v_mfma_f32_32x32x16_bf16 v[96:111], v[172:175], v[160:163], v[96:111]
    ds_read_b64_tr_b16 v[152:153], v36 offset:22528
    buffer_load_dwordx4 v15, s[52:55], s97 offen offset:1024 lds
    v_mfma_f32_32x32x16_bf16 v[80:95], v[168:171], v[164:167], v[80:95]
    ds_read_b64_tr_b16 v[154:155], v36 offset:23040
    ds_read_b64_tr_b16 v[156:157], v37 offset:22528
    v_mfma_f32_32x32x16_bf16 v[112:127], v[172:175], v[164:167], v[112:127]
    ds_read_b64_tr_b16 v[158:159], v37 offset:23040
    s_add_u32 m0, s64, 98304
    s_add_u32 s97, s33, 114688
    buffer_load_dwordx4 v14, s[52:55], s97 offen lds
    buffer_load_dwordx4 v15, s[52:55], s97 offen offset:1024 lds
    s_waitcnt lgkmcnt(0)
    s_barrier
    s_waitcnt vmcnt(16)
    v_cmp_ne_u32 s[100:101], s96, v31
    s_mov_b32 s99, 0x40000
    s_cmp_eq_u64 s[100:101], 0
    s_cbranch_scc1 L_pd3
L_pl3:
    s_mov_b64 exec, s[100:101]
    buffer_load_dword v31, v30, s[40:43], 0 offen sc1
    s_waitcnt vmcnt(0)
    v_cmp_ne_u32 s[100:101], s96, v31
    s_sub_u32 s99, s99, 1
    s_cselect_b64 s[100:101], 0, s[100:101]
    s_cmp_eq_u64 s[100:101], 0
    s_cbranch_scc0 L_pl3
    s_mov_b64 exec, -1
L_pd3:
    v_mfma_f32_32x32x16_bf16 v[80:95], v[136:139], v[132:135], v[80:95]
    v_mfma_f32_32x32x16_bf16 v[80:95], v[152:155], v[148:151], v[80:95]
    buffer_load_dword v62, v24, s[40:43], 0 offen sc1
    s_add_u32 m0, s64, 32768
    s_add_u32 s97, s19, 0
    buffer_load_dwordx4 v12, s[48:51], s97 offen lds
    buffer_load_dwordx4 v13, s[48:51], s97 offen offset:1024 lds
    s_lshl_b32 s10, s65, 2
    s_add_u32 s10, s10, s66
    s_lshl_b32 s10, s10, 2
    s_lshr_b32 s11, s4, 1
    v_mfma_f32_32x32x16_bf16 v[96:111], v[140:143], v[128:131], v[96:111]
    v_mfma_f32_32x32x16_bf16 v[96:111], v[156:159], v[144:147], v[96:111]
    s_xor_b32 s12, s11, 1
    s_add_u32 s12, s12, s10
    s_mul_i32 s12, s12, 24576
    s_add_u32 s12, s12, s64
    s_add_u32 s12, s12, 16777216
    v_cvt_pk_bf16_f32 v192, v80, v81
    v_cvt_pk_bf16_f32 v193, v82, v83
    v_cvt_pk_bf16_f32 v194, v84, v85
    v_cvt_pk_bf16_f32 v195, v86, v87
    buffer_store_dwordx4 v[192:195], v26, s[40:43], s12 offen offset:0 sc1
    v_cvt_pk_bf16_f32 v196, v88, v89
    v_cvt_pk_bf16_f32 v197, v90, v91
    v_cvt_pk_bf16_f32 v198, v92, v93
    v_cvt_pk_bf16_f32 v199, v94, v95
    buffer_store_dwordx4 v[196:199], v26, s[40:43], s12 offen offset:1024 sc1
    v_mfma_f32_32x32x16_bf16 v[112:127], v[140:143], v[132:135], v[112:127]
    v_mfma_f32_32x32x16_bf16 v[112:127], v[156:159], v[148:151], v[112:127]
    s_xor_b32 s12, s11, 2
    s_add_u32 s12, s12, s10
    s_mul_i32 s12, s12, 24576
    s_add_u32 s12, s12, s64
    s_add_u32 s12, s12, 16785408
    v_cvt_pk_bf16_f32 v200, v96, v97
    v_cvt_pk_bf16_f32 v201, v98, v99
    v_cvt_pk_bf16_f32 v202, v100, v101
    v_cvt_pk_bf16_f32 v203, v102, v103
    buffer_store_dwordx4 v[200:203], v26, s[40:43], s12 offen offset:0 sc1
    v_cvt_pk_bf16_f32 v204, v104, v105
    v_cvt_pk_bf16_f32 v205, v106, v107
    v_cvt_pk_bf16_f32 v206, v108, v109
    v_cvt_pk_bf16_f32 v207, v110, v111
    buffer_store_dwordx4 v[204:207], v26, s[40:43], s12 offen offset:1024 sc1
    v_mfma_f32_32x32x16_bf16 v[240:255], v[136:139], v[128:131], v[240:255]
    v_mfma_f32_32x32x16_bf16 v[240:255], v[152:155], v[144:147], v[240:255]
    s_xor_b32 s12, s11, 3
    s_add_u32 s12, s12, s10
    s_mul_i32 s12, s12, 24576
    s_add_u32 s12, s12, s64
    s_add_u32 s12, s12, 16793600
    v_cvt_pk_bf16_f32 v208, v112, v113
    v_cvt_pk_bf16_f32 v209, v114, v115
    v_cvt_pk_bf16_f32 v210, v116, v117
    v_cvt_pk_bf16_f32 v211, v118, v119
    buffer_store_dwordx4 v[208:211], v26, s[40:43], s12 offen offset:0 sc1
    v_cvt_pk_bf16_f32 v212, v120, v121
    v_cvt_pk_bf16_f32 v213, v122, v123
    v_cvt_pk_bf16_f32 v214, v124, v125
    v_cvt_pk_bf16_f32 v215, v126, v127
    buffer_store_dwordx4 v[212:215], v26, s[40:43], s12 offen offset:1024 sc1
    s_add_u32 s12, s10, s11
    s_mul_i32 s67, s12, 24576
    s_add_u32 s67, s67, s64
    s_add_u32 s67, s67, 16777216
    s_mov_b32 s70, 1
    s_branch L_p2
L_pf:
    v_lshrrev_b32 v6, 4, v1
    v_mul_u32_u24 v6, 2752, v6
    v_and_b32 v7, 15, v1
    v_lshlrev_b32 v7, 7, v7
    v_min_u32 v7, 1532, v7
    v_add_u32 v6, v6, v7
    s_sub_u32 s12, s5, 16
    s_lshl_b32 s12, s12, 4
    s_add_u32 s12, s12, s3
    s_lshr_b32 s13, s4, 1
    s_lshl_b32 s13, s13, 7
    s_add_u32 s12, s12, s13
    s_mul_i32 s12, s12, 11008
    s_and_b32 s13, s4, 1
    s_mul_i32 s13, s13, 1280
    s_add_u32 s12, s12, s13
    buffer_load_dword v63, v6, s[56:59], s12 offen
    v_mov_b32 v8, v6
    s_mov_b32 s9, s12
    s_waitcnt vmcnt(1)
    s_mov_b64 exec, 0xf
    buffer_store_dwordx2 v[56:57], v58, s[40:43], s37 offen sc1
    s_mov_b64 exec, -1
    s_barrier
    s_add_u32 s97, s9, 44032
    buffer_load_dword v63, v8, s[56:59], s97 offen
    s_add_u32 s97, s9, 88064
    buffer_load_dword v63, v8, s[56:59], s97 offen
    s_mov_b32 s52, s20
    s_mov_b32 s53, s21
    s_mov_b32 s54, 524288
    s_mov_b32 s55, 0x20000
    s_mov_b32 s48, s28
    s_mov_b32 s49, s29
    s_mov_b32 s50, 5636096
    s_mov_b32 s51, 0x20000
    s_and_b32 s17, s5, 7
    s_lshr_b32 s16, s5, 3
    s_add_u32 s16, s16, s17
    s_add_u32 s16, s16, 1
    s_and_b32 s16, s16, 3
    s_lshl_b32 s14, s4, 2
    s_add_u32 s16, s16, s14
    s_add_u32 s44, s38, 6291456
    s_addc_u32 s45, s39, 0
    s_mov_b32 s46, 1409024
    s_mov_b32 s47, 0x20000
    v_lshrrev_b32 v14, 3, v1
    v_mul_u32_u24 v14, 1024, v14
    v_bfe_u32 v2, v1, 4, 1
    v_lshlrev_b32 v2, 2, v2
    v_xor_b32 v2, v2, v1
    v_and_b32 v2, 7, v2
    v_lshl_add_u32 v14, v2, 4, v14
    v_add_u32 v15, 7168, v14
    v_lshrrev_b32 v12, 3, v1
    v_mul_u32_u24 v12, 4096, v12
    v_bfe_u32 v2, v1, 4, 1
    v_lshlrev_b32 v2, 2, v2
    v_xor_b32 v2, v2, v1
    v_and_b32 v2, 7, v2
    v_lshl_add_u32 v12, v2, 4, v12
    v_add_u32 v13, 31744, v12
    s_mul_i32 s33, s3, 131072
    s_lshl_b32 s14, s17, 7
    s_add_u32 s33, s33, s14
    s_lshl_b32 s32, s16, 16
    s_lshl_b32 s14, s3, 13
    s_add_u32 s32, s32, s14
    s_add_u32 s32, s32, 2097152
    s_add_u32 s36, s14, 4194304
    s_mov_b32 s6, 0
    s_mul_i32 s18, s3, 360448
    s_mul_i32 s19, s3, 1441792
    s_lshl_b32 s14, s16, 7
    s_add_u32 s19, s19, s14
    v_lshrrev_b32 v2, 5, v1
    v_lshlrev_b32 v2, 13, v2
    v_and_b32 v3, 31, v1
    v_lshl_add_u32 v2, v3, 4, v2
    s_lshl_b32 s14, s17, 10
    v_add_u32 v8, s14, v2
    v_add_u32 v9, 512, v8
    v_lshlrev_b32 v10, 4, v1
    v_add_u32 v11, 32768, v10
    v_lshrrev_b32 v16, 5, v1
    v_lshlrev_b32 v16, 9, v16
    v_bfe_u32 v2, v1, 2, 2
    v_lshl_add_u32 v16, v2, 7, v16
    v_bfe_u32 v2, v1, 3, 1
    v_lshl_add_u32 v16, v2, 6, v16
    v_bfe_u32 v2, v1, 4, 1
    v_lshl_add_u32 v16, v2, 5, v16
    v_and_b32 v2, 3, v1
    v_lshl_add_u32 v16, v2, 3, v16
    v_add_u32 v16, s64, v16
    v_xor_b32 v17, 64, v16
    v_add_u32 v18, 65536, v16
    v_add_u32 v19, 65536, v17
    v_add_u32 v20, 131072, v16
    v_add_u32 v21, 131072, v17
    v_bfe_u32 v2, v1, 3, 2
    v_lshlrev_b32 v2, 6, v2
    v_and_b32 v3, 3, v1
    v_lshl_add_u32 v2, v3, 3, v2
    v_bfe_u32 v3, v1, 2, 1
    v_lshl_add_u32 v2, v3, 14, v2
    s_lshl_b32 s14, s16, 9
    s_add_u32 s14, s14, 11534336
    v_add_u32 v22, s14, v2
    v_add_u32 v23, 256, v22
    s_lshl_b32 s14, s16, 2
    s_add_u32 s14, s14, s3
    s_lshl_b32 s14, s14, 7
    s_add_u32 s14, s14, 11632640
    v_and_b32 v3, 1, v1
    v_lshl_add_u32 v24, v3, 6, s14
    s_lshl_b32 s14, s17, 13
    s_mul_i32 s15, s3, 1408
    s_add_u32 s14, s14, s15
    s_add_u32 s14, s14, 11649024
    v_min_u32 v25, 21, v1
    v_lshl_add_u32 v25, v25, 6, s14
    v_lshrrev_b32 v6, 2, v1
    v_lshlrev_b32 v6, 12, v6
    v_and_b32 v7, 3, v1
    v_lshl_add_u32 v6, v7, 7, v6
    s_sub_u32 s8, s5, 16
    s_mul_i32 s12, s3, 1441792
    s_lshl_b32 s13, s4, 9
    s_add_u32 s12, s12, s13
    s_add_u32 s13, s8, s6
    s_add_u32 s97, s13, 0
    s_cmp_ge_u32 s97, 22
    s_cselect_b32 s99, 22, 0
    s_sub_u32 s97, s97, s99
    s_lshl_b32 s97, s97, 16
    s_add_u32 s97, s97, s12
    buffer_load_dword v63, v6, s[48:51], s97 offen
    s_cmp_lt_u32 s5, 22
    s_cbranch_scc0 L_red
    s_and_b32 s66, s4, 1
    s_mul_i32 s66, s66, 22
    s_add_u32 s66, s66, s5
    s_lshr_b32 s65, s66, 2
    s_and_b32 s66, s66, 3
    s_lshl_b32 s23, s66, 1
    s_add_u32 s23, s23, s65
    v_lshlrev_b32 v26, 4, v1
    v_add_u32 v27, 6144, v26
    v_lshrrev_b32 v28, 3, v1
    v_mul_u32_u24 v28, 2752, v28
    v_bfe_u32 v3, v1, 4, 1
    v_lshlrev_b32 v3, 2, v3
    v_xor_b32 v3, v3, v1
    v_and_b32 v3, 7, v3
    v_lshl_add_u32 v28, v3, 4, v28
    v_add_u32 v29, 20992, v28
    s_lshr_b32 s10, s4, 1
    s_lshl_b32 s67, s10, 19
    s_lshl_b32 s11, s3, 14
    s_add_u32 s67, s67, s11
    s_lshl_b32 s11, s66, 11
    s_add_u32 s67, s67, s11
    s_lshl_b32 s68, s10, 5
    s_add_u32 s68, s68, s3
    s_mul_i32 s68, s68, 44032
    s_lshl_b32 s11, s65, 8
    s_add_u32 s68, s68, s11
    v_lshrrev_b32 v2, 5, v1
    v_lshlrev_b32 v2, 11, v2
    v_and_b32 v3, 31, v1
    v_lshl_add_u32 v2, v3, 4, v2
    s_and_b32 s11, s3, 1
    s_lshl_b32 s11, s11, 10
    s_and_b32 s12, s10, 1
    s_lshl_b32 s12, s12, 9
    s_add_u32 s11, s11, s12
    v_add_u32 v32, s11, v2
    v_xor_b32 v33, 512, v32
    v_add_u32 v34, 0x10000, v32
    v_add_u32 v35, 0x10000, v33
    v_lshrrev_b32 v36, 5, v1
    v_lshlrev_b32 v36, 10, v36
    v_bfe_u32 v3, v1, 2, 2
    v_lshl_add_u32 v36, v3, 7, v36
    v_bfe_u32 v3, v1, 3, 1
    v_lshl_add_u32 v36, v3, 6, v36
    v_bfe_u32 v3, v1, 4, 1
    v_lshl_add_u32 v36, v3, 5, v36
    v_and_b32 v3, 3, v1
    v_lshl_add_u32 v36, v3, 3, v36
    s_lshr_b32 s11, s3, 1
    s_lshl_b32 s11, s11, 13
    s_lshr_b32 s12, s10, 1
    s_lshl_b32 s12, s12, 6
    v_xor_b32 v36, s12, v36
    v_add_u32 v36, s11, v36
    v_xor_b32 v37, 64, v36
    v_add_u32 v38, 0x10000, v36
    v_add_u32 v39, 0x10000, v37
    s_mov_b32 s60, s26
    s_mov_b32 s61, s27
    s_mov_b32 s62, 2752
    s_mov_b32 s63, 0x20000
    s_lshl_b32 s10, s10, 12
    s_add_u32 s10, s10, 11534336
    s_lshr_b32 s11, s66, 1
    s_lshl_b32 s11, s11, 14
    s_add_u32 s10, s10, s11
    v_lshlrev_b32 v30, 6, v1
    v_add_u32 v30, s10, v30
    v_lshrrev_b32 v2, 5, v1
    v_lshlrev_b32 v2, 3, v2
    s_lshl_b32 s97, s65, 8
    s_lshr_b32 s98, s3, 1
    s_lshl_b32 s98, s98, 7
    s_add_u32 s97, s97, s98
    s_lshr_b32 s98, s4, 2
    s_lshl_b32 s98, s98, 6
    s_add_u32 s97, s97, s98
    buffer_load_dwordx2 v[48:49], v2, s[60:63], s97 offen offset:0
    buffer_load_dwordx2 v[50:51], v2, s[60:63], s97 offen offset:16
    buffer_load_dwordx2 v[52:53], v2, s[60:63], s97 offen offset:32
    buffer_load_dwordx2 v[54:55], v2, s[60:63], s97 offen offset:48
    buffer_load_dword v31, v30, s[40:43], 0 offen sc1
    s_waitcnt vmcnt(1)
    v_lshlrev_b32 v240, 16, v48
    v_and_b32 v241, 0xffff0000, v48
    v_lshlrev_b32 v242, 16, v49
    v_and_b32 v243, 0xffff0000, v49
    v_lshlrev_b32 v244, 16, v50
    v_and_b32 v245, 0xffff0000, v50
    v_lshlrev_b32 v246, 16, v51
    v_and_b32 v247, 0xffff0000, v51
    v_lshlrev_b32 v248, 16, v52
    v_and_b32 v249, 0xffff0000, v52
    v_lshlrev_b32 v250, 16, v53
    v_and_b32 v251, 0xffff0000, v53
    v_lshlrev_b32 v252, 16, v54
    v_and_b32 v253, 0xffff0000, v54
    v_lshlrev_b32 v254, 16, v55
    v_and_b32 v255, 0xffff0000, v55
    s_waitcnt vmcnt(0)
    v_cmp_ne_u32 s[100:101], s96, v31
    s_mov_b32 s99, 0x40000
    s_cmp_eq_u64 s[100:101], 0
    s_cbranch_scc1 L_pd4
L_pl4:
    s_mov_b64 exec, s[100:101]
    buffer_load_dword v31, v30, s[40:43], 0 offen sc1
    s_waitcnt vmcnt(0)
    v_cmp_ne_u32 s[100:101], s96, v31
    s_sub_u32 s99, s99, 1
    s_cselect_b64 s[100:101], 0, s[100:101]
    s_cmp_eq_u64 s[100:101], 0
    s_cbranch_scc0 L_pl4
    s_mov_b64 exec, -1
L_pd4:
    s_lshl_b32 s97, s64, 1
    s_add_u32 m0, s97, 65536
    s_add_u32 s98, s23, 0
    s_and_b32 s98, s98, 7
    s_lshl_b32 s97, s98, 16
    s_add_u32 s97, s97, s67
    s_mul_i32 s98, s98, 176128
    s_add_u32 s98, s98, s68
    buffer_load_dwordx4 v26, s[40:43], s97 offen offset:0 sc1 lds
    buffer_load_dwordx4 v26, s[40:43], s97 offen offset:1024 sc1 lds
    buffer_load_dwordx4 v27, s[40:43], s97 offen offset:2048 sc1 lds
    buffer_load_dwordx4 v27, s[40:43], s97 offen offset:3072 sc1 lds
    s_add_u32 m0, s64, 81920
    s_nop 0
    buffer_load_dwordx4 v28, s[56:59], s98 offen offset:0 lds
    s_add_u32 m0, s64, 89984
    s_nop 0
    buffer_load_dwordx4 v28, s[56:59], s98 offen offset:128 lds
    s_add_u32 m0, s64, 81920
    s_nop 0
    buffer_load_dwordx4 v29, s[56:59], s98 offen offset:1024 lds
    s_add_u32 m0, s64, 89984
    s_nop 0
    buffer_load_dwordx4 v29, s[56:59], s98 offen offset:1152 lds
    s_lshl_b32 s97, s64, 1
    s_add_u32 m0, s97, 0
    s_add_u32 s98, s23, 1
    s_and_b32 s98, s98, 7
    s_lshl_b32 s97, s98, 16
    s_add_u32 s97, s97, s67
    s_mul_i32 s98, s98, 176128
    s_add_u32 s98, s98, s68
    buffer_load_dwordx4 v26, s[40:43], s97 offen offset:0 sc1 lds
    buffer_load_dwordx4 v26, s[40:43], s97 offen offset:1024 sc1 lds
    buffer_load_dwordx4 v27, s[40:43], s97 offen offset:2048 sc1 lds
    buffer_load_dwordx4 v27, s[40:43], s97 offen offset:3072 sc1 lds
    s_add_u32 m0, s64, 16384
    s_nop 0
    buffer_load_dwordx4 v28, s[56:59], s98 offen offset:0 lds
    s_add_u32 m0, s64, 24448
    s_nop 0
    buffer_load_dwordx4 v28, s[56:59], s98 offen offset:128 lds
    s_add_u32 m0, s64, 16384
    s_nop 0
    buffer_load_dwordx4 v29, s[56:59], s98 offen offset:1024 lds
    s_add_u32 m0, s64, 24448
    s_nop 0
    buffer_load_dwordx4 v29, s[56:59], s98 offen offset:1152 lds
    s_lshl_b32 s97, s64, 1
    s_add_u32 m0, s97, 32768
    s_add_u32 s98, s23, 2
    s_and_b32 s98, s98, 7
    s_lshl_b32 s97, s98, 16
    s_add_u32 s97, s97, s67
    s_mul_i32 s98, s98, 176128
    s_add_u32 s98, s98, s68
    buffer_load_dwordx4 v26, s[40:43], s97 offen offset:0 sc1 lds
    buffer_load_dwordx4 v26, s[40:43], s97 offen offset:1024 sc1 lds
    buffer_load_dwordx4 v27, s[40:43], s97 offen offset:2048 sc1 lds
    buffer_load_dwordx4 v27, s[40:43], s97 offen offset:3072 sc1 lds
    s_add_u32 m0, s64, 49152
    s_nop 0
    buffer_load_dwordx4 v28, s[56:59], s98 offen offset:0 lds
    s_add_u32 m0, s64, 57216
    s_nop 0
    buffer_load_dwordx4 v28, s[56:59], s98 offen offset:128 lds
    s_add_u32 m0, s64, 49152
    s_nop 0
    buffer_load_dwordx4 v29, s[56:59], s98 offen offset:1024 lds
    s_add_u32 m0, s64, 57216
    s_nop 0
    buffer_load_dwordx4 v29, s[56:59], s98 offen offset:1152 lds
    s_waitcnt vmcnt(16)
    s_barrier
    ds_read_b128 v[128:131], v34 offset:0
    ds_read_b128 v[132:135], v35 offset:0
    ds_read_b64_tr_b16 v[136:137], v38 offset:16384
    ds_read_b64_tr_b16 v[138:139], v38 offset:16896
    ds_read_b64_tr_b16 v[140:141], v39 offset:16384
    ds_read_b64_tr_b16 v[142:143], v39 offset:16896
    ds_read_b128 v[144:147], v34 offset:4096
    ds_read_b128 v[148:151], v35 offset:4096
    ds_read_b64_tr_b16 v[152:153], v38 offset:18432
    ds_read_b64_tr_b16 v[154:155], v38 offset:18944
    ds_read_b64_tr_b16 v[156:157], v39 offset:18432
    ds_read_b64_tr_b16 v[158:159], v39 offset:18944
    s_waitcnt lgkmcnt(6)
    v_mfma_f32_32x32x16_bf16 v[240:255], v[136:139], v[128:131], v[240:255]
    ds_read_b128 v[160:163], v34 offset:8192
    ds_read_b128 v[164:167], v35 offset:8192
    v_mfma_f32_32x32x16_bf16 v[96:111], v[140:143], v[128:131], 0
    ds_read_b64_tr_b16 v[168:169], v38 offset:20480
    ds_read_b64_tr_b16 v[170:171], v38 offset:20992
    v_mfma_f32_32x32x16_bf16 v[80:95], v[136:139], v[132:135], 0
    ds_read_b64_tr_b16 v[172:173], v39 offset:20480
    ds_read_b64_tr_b16 v[174:175], v39 offset:20992
    v_mfma_f32_32x32x16_bf16 v[112:127], v[140:143], v[132:135], 0
    s_mov_b32 s60, s30
    s_mov_b32 s61, s31
    s_mov_b32 s62, 4096
    s_mov_b32 s63, 0x20000
    s_lshl_b32 s14, s16, 7
    v_and_b32 v2, 31, v1
    v_lshlrev_b32 v2, 1, v2
    buffer_load_ushort v46, v2, s[60:63], s14 offen
    buffer_load_ushort v47, v2, s[60:63], s14 offen offset:64
    buffer_load_dwordx2 v[56:57], v22, s[40:43], 0 offen sc1
    buffer_load_dwordx2 v[58:59], v23, s[40:43], 0 offen sc1
    s_waitcnt lgkmcnt(6)
    v_mfma_f32_32x32x16_bf16 v[240:255], v[152:155], v[144:147], v[240:255]
    ds_read_b128 v[128:131], v34 offset:12288
    ds_read_b128 v[132:135], v35 offset:12288
    v_mfma_f32_32x32x16_bf16 v[96:111], v[156:159], v[144:147], v[96:111]
    ds_read_b64_tr_b16 v[136:137], v38 offset:22528
    v_mfma_f32_32x32x16_bf16 v[80:95], v[152:155], v[148:151], v[80:95]
    ds_read_b64_tr_b16 v[138:139], v38 offset:23040
    ds_read_b64_tr_b16 v[140:141], v39 offset:22528
    v_mfma_f32_32x32x16_bf16 v[112:127], v[156:159], v[148:151], v[112:127]
    ds_read_b64_tr_b16 v[142:143], v39 offset:23040
    s_waitcnt lgkmcnt(6)
    v_mfma_f32_32x32x16_bf16 v[240:255], v[168:171], v[160:163], v[240:255]
    v_mfma_f32_32x32x16_bf16 v[96:111], v[172:175], v[160:163], v[96:111]
    s_lshl_b32 s97, s64, 1
    s_add_u32 m0, s97, 65536
    s_add_u32 s98, s23, 3
    s_and_b32 s98, s98, 7
    s_lshl_b32 s97, s98, 16
    s_add_u32 s97, s97, s67
    s_mul_i32 s98, s98, 176128
    s_add_u32 s98, s98, s68
    s_waitcnt vmcnt(12) lgkmcnt(0)
    s_barrier
    v_mfma_f32_32x32x16_bf16 v[80:95], v[168:171], v[164:167], v[80:95]
    ds_read_b128 v[144:147], v32 offset:0
    ds_read_b128 v[148:151], v33 offset:0
    ds_read_b64_tr_b16 v[152:153], v36 offset:16384
    ds_read_b64_tr_b16 v[154:155], v36 offset:16896
    v_mfma_f32_32x32x16_bf16 v[112:127], v[172:175], v[164:167], v[112:127]
    ds_read_b64_tr_b16 v[156:157], v37 offset:16384
    ds_read_b64_tr_b16 v[158:159], v37 offset:16896
    buffer_load_dwordx4 v26, s[40:43], s97 offen offset:0 sc1 lds
    v_mfma_f32_32x32x16_bf16 v[240:255], v[136:139], v[128:131], v[240:255]
    ds_read_b128 v[160:163], v32 offset:4096
    ds_read_b128 v[164:167], v33 offset:4096
    v_mfma_f32_32x32x16_bf16 v[96:111], v[140:143], v[128:131], v[96:111]
    ds_read_b64_tr_b16 v[168:169], v36 offset:18432
    buffer_load_dwordx4 v26, s[40:43], s97 offen offset:1024 sc1 lds
    v_mfma_f32_32x32x16_bf16 v[80:95], v[136:139], v[132:135], v[80:95]
    ds_read_b64_tr_b16 v[170:171], v36 offset:18944
    ds_read_b64_tr_b16 v[172:173], v37 offset:18432
    v_mfma_f32_32x32x16_bf16 v[112:127], v[140:143], v[132:135], v[112:127]
    ds_read_b64_tr_b16 v[174:175], v37 offset:18944
    buffer_load_dwordx4 v27, s[40:43], s97 offen offset:2048 sc1 lds
    s_waitcnt lgkmcnt(6)
    v_mfma_f32_32x32x16_bf16 v[240:255], v[152:155], v[144:147], v[240:255]
    ds_read_b128 v[128:131], v32 offset:8192
    ds_read_b128 v[132:135], v33 offset:8192
    v_mfma_f32_32x32x16_bf16 v[96:111], v[156:159], v[144:147], v[96:111]
    ds_read_b64_tr_b16 v[136:137], v36 offset:20480
    buffer_load_dwordx4 v27, s[40:43], s97 offen offset:3072 sc1 lds
    v_mfma_f32_32x32x16_bf16 v[80:95], v[152:155], v[148:151], v[80:95]
    ds_read_b64_tr_b16 v[138:139], v36 offset:20992
    ds_read_b64_tr_b16 v[140:141], v37 offset:20480
    v_mfma_f32_32x32x16_bf16 v[112:127], v[156:159], v[148:151], v[112:127]
    ds_read_b64_tr_b16 v[142:143], v37 offset:20992
    s_add_u32 m0, s64, 81920
    s_nop 0
    buffer_load_dwordx4 v28, s[56:59], s98 offen offset:0 lds
    s_waitcnt lgkmcnt(6)
    v_mfma_f32_32x32x16_bf16 v[240:255], v[168:171], v[160:163], v[240:255]
    ds_read_b128 v[144:147], v32 offset:12288
    ds_read_b128 v[148:151], v33 offset:12288
    v_mfma_f32_32x32x16_bf16 v[96:111], v[172:175], v[160:163], v[96:111]
    ds_read_b64_tr_b16 v[152:153], v36 offset:22528
    s_add_u32 m0, s64, 89984
    s_nop 0
    buffer_load_dwordx4 v28, s[56:59], s98 offen offset:128 lds
    v_mfma_f32_32x32x16_bf16 v[80:95], v[168:171], v[164:167], v[80:95]
    ds_read_b64_tr_b16 v[154:155], v36 offset:23040
    ds_read_b64_tr_b16 v[156:157], v37 offset:22528
    v_mfma_f32_32x32x16_bf16 v[112:127], v[172:175], v[164:167], v[112:127]
    ds_read_b64_tr_b16 v[158:159], v37 offset:23040
    s_add_u32 m0, s64, 81920
    s_nop 0
    buffer_load_dwordx4 v29, s[56:59], s98 offen offset:1024 lds
    s_waitcnt lgkmcnt(6)
    v_mfma_f32_32x32x16_bf16 v[240:255], v[136:139], v[128:131], v[240:255]
    s_add_u32 m0, s64, 89984
    s_nop 0
    buffer_load_dwordx4 v29, s[56:59], s98 offen offset:1152 lds
    v_mfma_f32_32x32x16_bf16 v[96:111], v[140:143], v[128:131], v[96:111]
    s_lshl_b32 s97, s64, 1
    s_add_u32 m0, s97, 0
    s_add_u32 s98, s23, 4
    s_and_b32 s98, s98, 7
    s_lshl_b32 s97, s98, 16
    s_add_u32 s97, s97, s67
    s_mul_i32 s98, s98, 176128
    s_add_u32 s98, s98, s68
    s_waitcnt vmcnt(12) lgkmcnt(0)
    s_barrier
    v_mfma_f32_32x32x16_bf16 v[80:95], v[136:139], v[132:135], v[80:95]
    ds_read_b128 v[160:163], v32 offset:32768
    ds_read_b128 v[164:167], v33 offset:32768
    ds_read_b64_tr_b16 v[168:169], v36 offset:49152
    ds_read_b64_tr_b16 v[170:171], v36 offset:49664
    v_mfma_f32_32x32x16_bf16 v[112:127], v[140:143], v[132:135], v[112:127]
    ds_read_b64_tr_b16 v[172:173], v37 offset:49152
    ds_read_b64_tr_b16 v[174:175], v37 offset:49664
    buffer_load_dwordx4 v26, s[40:43], s97 offen offset:0 sc1 lds
    v_mfma_f32_32x32x16_bf16 v[240:255], v[152:155], v[144:147], v[240:255]
    ds_read_b128 v[128:131], v32 offset:36864
    ds_read_b128 v[132:135], v33 offset:36864
    v_mfma_f32_32x32x16_bf16 v[96:111], v[156:159], v[144:147], v[96:111]
    ds_read_b64_tr_b16 v[136:137], v36 offset:51200
    buffer_load_dwordx4 v26, s[40:43], s97 offen offset:1024 sc1 lds
    v_mfma_f32_32x32x16_bf16 v[80:95], v[152:155], v[148:151], v[80:95]
    ds_read_b64_tr_b16 v[138:139], v36 offset:51712
    ds_read_b64_tr_b16 v[140:141], v37 offset:51200
    v_mfma_f32_32x32x16_bf16 v[112:127], v[156:159], v[148:151], v[112:127]
    ds_read_b64_tr_b16 v[142:143], v37 offset:51712
    buffer_load_dwordx4 v27, s[40:43], s97 offen offset:2048 sc1 lds
    s_waitcnt lgkmcnt(6)
    v_mfma_f32_32x32x16_bf16 v[240:255], v[168:171], v[160:163], v[240:255]
    ds_read_b128 v[144:147], v32 offset:40960
    ds_read_b128 v[148:151], v33 offset:40960
    v_mfma_f32_32x32x16_bf16 v[96:111], v[172:175], v[160:163], v[96:111]
    ds_read_b64_tr_b16 v[152:153], v36 offset:53248
    buffer_load_dwordx4 v27, s[40:43], s97 offen offset:3072 sc1 lds
    v_mfma_f32_32x32x16_bf16 v[80:95], v[168:171], v[164:167], v[80:95]
    ds_read_b64_tr_b16 v[154:155], v36 offset:53760
    ds_read_b64_tr_b16 v[156:157], v37 offset:53248
    v_mfma_f32_32x32x16_bf16 v[112:127], v[172:175], v[164:167], v[112:127]
    ds_read_b64_tr_b16 v[158:159], v37 offset:53760
    s_add_u32 m0, s64, 16384
    s_nop 0
    buffer_load_dwordx4 v28, s[56:59], s98 offen offset:0 lds
    s_waitcnt lgkmcnt(6)
    v_mfma_f32_32x32x16_bf16 v[240:255], v[136:139], v[128:131], v[240:255]
    ds_read_b128 v[160:163], v32 offset:45056
    ds_read_b128 v[164:167], v33 offset:45056
    v_mfma_f32_32x32x16_bf16 v[96:111], v[140:143], v[128:131], v[96:111]
    ds_read_b64_tr_b16 v[168:169], v36 offset:55296
    s_add_u32 m0, s64, 24448
    s_nop 0
    buffer_load_dwordx4 v28, s[56:59], s98 offen offset:128 lds
    v_mfma_f32_32x32x16_bf16 v[80:95], v[136:139], v[132:135], v[80:95]
    ds_read_b64_tr_b16 v[170:171], v36 offset:55808
    ds_read_b64_tr_b16 v[172:173], v37 offset:55296
    v_mfma_f32_32x32x16_bf16 v[112:127], v[140:143], v[132:135], v[112:127]
    ds_read_b64_tr_b16 v[174:175], v37 offset:55808
    s_add_u32 m0, s64, 16384
    s_nop 0
    buffer_load_dwordx4 v29, s[56:59], s98 offen offset:1024 lds
    s_waitcnt lgkmcnt(6)
    v_mfma_f32_32x32x16_bf16 v[240:255], v[152:155], v[144:147], v[240:255]
    s_add_u32 m0, s64, 24448
    s_nop 0
    buffer_load_dwordx4 v29, s[56:59], s98 offen offset:1152 lds
    v_mfma_f32_32x32x16_bf16 v[96:111], v[156:159], v[144:147], v[96:111]
    s_lshl_b32 s97, s64, 1
    s_add_u32 m0, s97, 32768
    s_add_u32 s98, s23, 5
    s_and_b32 s98, s98, 7
    s_lshl_b32 s97, s98, 16
    s_add_u32 s97, s97, s67
    s_mul_i32 s98, s98, 176128
    s_add_u32 s98, s98, s68
    s_waitcnt vmcnt(8) lgkmcnt(0)
    s_barrier
    v_mfma_f32_32x32x16_bf16 v[80:95], v[152:155], v[148:151], v[80:95]
    ds_read_b128 v[128:131], v34 offset:0
    ds_read_b128 v[132:135], v35 offset:0
    ds_read_b64_tr_b16 v[136:137], v38 offset:16384
    ds_read_b64_tr_b16 v[138:139], v38 offset:16896
    v_mfma_f32_32x32x16_bf16 v[112:127], v[156:159], v[148:151], v[112:127]
    ds_read_b64_tr_b16 v[140:141], v39 offset:16384
    ds_read_b64_tr_b16 v[142:143], v39 offset:16896
    buffer_load_dwordx4 v26, s[40:43], s97 offen offset:0 sc1 lds
    v_mfma_f32_32x32x16_bf16 v[240:255], v[168:171], v[160:163], v[240:255]
    ds_read_b128 v[144:147], v34 offset:4096
    ds_read_b128 v[148:151], v35 offset:4096
    v_mfma_f32_32x32x16_bf16 v[96:111], v[172:175], v[160:163], v[96:111]
    ds_read_b64_tr_b16 v[152:153], v38 offset:18432
    buffer_load_dwordx4 v26, s[40:43], s97 offen offset:1024 sc1 lds
    v_mfma_f32_32x32x16_bf16 v[80:95], v[168:171], v[164:167], v[80:95]
    ds_read_b64_tr_b16 v[154:155], v38 offset:18944
    ds_read_b64_tr_b16 v[156:157], v39 offset:18432
    v_mfma_f32_32x32x16_bf16 v[112:127], v[172:175], v[164:167], v[112:127]
    ds_read_b64_tr_b16 v[158:159], v39 offset:18944
    buffer_load_dwordx4 v27, s[40:43], s97 offen offset:2048 sc1 lds
    s_waitcnt lgkmcnt(6)
    v_mfma_f32_32x32x16_bf16 v[240:255], v[136:139], v[128:131], v[240:255]
    ds_read_b128 v[160:163], v34 offset:8192
    ds_read_b128 v[164:167], v35 offset:8192
    v_mfma_f32_32x32x16_bf16 v[96:111], v[140:143], v[128:131], v[96:111]
    ds_read_b64_tr_b16 v[168:169], v38 offset:20480
    buffer_load_dwordx4 v27, s[40:43], s97 offen offset:3072 sc1 lds
    v_mfma_f32_32x32x16_bf16 v[80:95], v[136:139], v[132:135], v[80:95]
    ds_read_b64_tr_b16 v[170:171], v38 offset:20992
    ds_read_b64_tr_b16 v[172:173], v39 offset:20480
    v_mfma_f32_32x32x16_bf16 v[112:127], v[140:143], v[132:135], v[112:127]
    ds_read_b64_tr_b16 v[174:175], v39 offset:20992
    s_add_u32 m0, s64, 49152
    s_nop 0
    buffer_load_dwordx4 v28, s[56:59], s98 offen offset:0 lds
    s_waitcnt lgkmcnt(6)
    v_mfma_f32_32x32x16_bf16 v[240:255], v[152:155], v[144:147], v[240:255]
    ds_read_b128 v[128:131], v34 offset:12288
    ds_read_b128 v[132:135], v35 offset:12288
    v_mfma_f32_32x32x16_bf16 v[96:111], v[156:159], v[144:147], v[96:111]
    ds_read_b64_tr_b16 v[136:137], v38 offset:22528
    s_add_u32 m0, s64, 57216
    s_nop 0
    buffer_load_dwordx4 v28, s[56:59], s98 offen offset:128 lds
    v_mfma_f32_32x32x16_bf16 v[80:95], v[152:155], v[148:151], v[80:95]
    ds_read_b64_tr_b16 v[138:139], v38 offset:23040
    ds_read_b64_tr_b16 v[140:141], v39 offset:22528
    v_mfma_f32_32x32x16_bf16 v[112:127], v[156:159], v[148:151], v[112:127]
    ds_read_b64_tr_b16 v[142:143], v39 offset:23040
    s_add_u32 m0, s64, 49152
    s_nop 0
    buffer_load_dwordx4 v29, s[56:59], s98 offen offset:1024 lds
    s_waitcnt lgkmcnt(6)
    v_mfma_f32_32x32x16_bf16 v[240:255], v[168:171], v[160:163], v[240:255]
    s_add_u32 m0, s64, 57216
    s_nop 0
    buffer_load_dwordx4 v29, s[56:59], s98 offen offset:1152 lds
    v_mfma_f32_32x32x16_bf16 v[96:111], v[172:175], v[160:163], v[96:111]
    s_lshl_b32 s97, s64, 1
    s_add_u32 m0, s97, 65536
    s_add_u32 s98, s23, 6
    s_and_b32 s98, s98, 7
    s_lshl_b32 s97, s98, 16
    s_add_u32 s97, s97, s67
    s_mul_i32 s98, s98, 176128
    s_add_u32 s98, s98, s68
    s_waitcnt vmcnt(8) lgkmcnt(0)
    s_barrier
    v_mfma_f32_32x32x16_bf16 v[80:95], v[168:171], v[164:167], v[80:95]
    ds_read_b128 v[144:147], v32 offset:0
    ds_read_b128 v[148:151], v33 offset:0
    ds_read_b64_tr_b16 v[152:153], v36 offset:16384
    ds_read_b64_tr_b16 v[154:155], v36 offset:16896
    v_mfma_f32_32x32x16_bf16 v[112:127], v[172:175], v[164:167], v[112:127]
    ds_read_b64_tr_b16 v[156:157], v37 offset:16384
    ds_read_b64_tr_b16 v[158:159], v37 offset:16896
    buffer_load_dwordx4 v26, s[40:43], s97 offen offset:0 sc1 lds
    v_mfma_f32_32x32x16_bf16 v[240:255], v[136:139], v[128:131], v[240:255]
    ds_read_b128 v[160:163], v32 offset:4096
    ds_read_b128 v[164:167], v33 offset:4096
    v_mfma_f32_32x32x16_bf16 v[96:111], v[140:143], v[128:131], v[96:111]
    ds_read_b64_tr_b16 v[168:169], v36 offset:18432
    buffer_load_dwordx4 v26, s[40:43], s97 offen offset:1024 sc1 lds
    v_mfma_f32_32x32x16_bf16 v[80:95], v[136:139], v[132:135], v[80:95]
    ds_read_b64_tr_b16 v[170:171], v36 offset:18944
    ds_read_b64_tr_b16 v[172:173], v37 offset:18432
    v_mfma_f32_32x32x16_bf16 v[112:127], v[140:143], v[132:135], v[112:127]
    ds_read_b64_tr_b16 v[174:175], v37 offset:18944
    buffer_load_dwordx4 v27, s[40:43], s97 offen offset:2048 sc1 lds
    s_waitcnt lgkmcnt(6)
    v_mfma_f32_32x32x16_bf16 v[240:255], v[152:155], v[144:147], v[240:255]
    ds_read_b128 v[128:131], v32 offset:8192
    ds_read_b128 v[132:135], v33 offset:8192
    v_mfma_f32_32x32x16_bf16 v[96:111], v[156:159], v[144:147], v[96:111]
    ds_read_b64_tr_b16 v[136:137], v36 offset:20480
    buffer_load_dwordx4 v27, s[40:43], s97 offen offset:3072 sc1 lds
    v_mfma_f32_32x32x16_bf16 v[80:95], v[152:155], v[148:151], v[80:95]
    ds_read_b64_tr_b16 v[138:139], v36 offset:20992
    ds_read_b64_tr_b16 v[140:141], v37 offset:20480
    v_mfma_f32_32x32x16_bf16 v[112:127], v[156:159], v[148:151], v[112:127]
    ds_read_b64_tr_b16 v[142:143], v37 offset:20992
    s_add_u32 m0, s64, 81920
    s_nop 0
    buffer_load_dwordx4 v28, s[56:59], s98 offen offset:0 lds
    s_waitcnt lgkmcnt(6)
    v_mfma_f32_32x32x16_bf16 v[240:255], v[168:171], v[160:163], v[240:255]
    ds_read_b128 v[144:147], v32 offset:12288
    ds_read_b128 v[148:151], v33 offset:12288
    v_mfma_f32_32x32x16_bf16 v[96:111], v[172:175], v[160:163], v[96:111]
    ds_read_b64_tr_b16 v[152:153], v36 offset:22528
    s_add_u32 m0, s64, 89984
    s_nop 0
    buffer_load_dwordx4 v28, s[56:59], s98 offen offset:128 lds
    v_mfma_f32_32x32x16_bf16 v[80:95], v[168:171], v[164:167], v[80:95]
    ds_read_b64_tr_b16 v[154:155], v36 offset:23040
    ds_read_b64_tr_b16 v[156:157], v37 offset:22528
    v_mfma_f32_32x32x16_bf16 v[112:127], v[172:175], v[164:167], v[112:127]
    ds_read_b64_tr_b16 v[158:159], v37 offset:23040
    s_add_u32 m0, s64, 81920
    s_nop 0
    buffer_load_dwordx4 v29, s[56:59], s98 offen offset:1024 lds
    s_waitcnt lgkmcnt(6)
    v_mfma_f32_32x32x16_bf16 v[240:255], v[136:139], v[128:131], v[240:255]
    s_add_u32 m0, s64, 89984
    s_nop 0
    buffer_load_dwordx4 v29, s[56:59], s98 offen offset:1152 lds
    v_mfma_f32_32x32x16_bf16 v[96:111], v[140:143], v[128:131], v[96:111]
    s_lshl_b32 s97, s64, 1
    s_add_u32 m0, s97, 0
    s_add_u32 s98, s23, 7
    s_and_b32 s98, s98, 7
    s_lshl_b32 s97, s98, 16
    s_add_u32 s97, s97, s67
    s_mul_i32 s98, s98, 176128
    s_add_u32 s98, s98, s68
    s_waitcnt vmcnt(8) lgkmcnt(0)
    s_barrier
    v_mfma_f32_32x32x16_bf16 v[80:95], v[136:139], v[132:135], v[80:95]
    ds_read_b128 v[160:163], v32 offset:32768
    ds_read_b128 v[164:167], v33 offset:32768
    ds_read_b64_tr_b16 v[168:169], v36 offset:49152
    ds_read_b64_tr_b16 v[170:171], v36 offset:49664
    v_mfma_f32_32x32x16_bf16 v[112:127], v[140:143], v[132:135], v[112:127]
    ds_read_b64_tr_b16 v[172:173], v37 offset:49152
    ds_read_b64_tr_b16 v[174:175], v37 offset:49664
    buffer_load_dwordx4 v26, s[40:43], s97 offen offset:0 sc1 lds
    v_mfma_f32_32x32x16_bf16 v[240:255], v[152:155], v[144:147], v[240:255]
    ds_read_b128 v[128:131], v32 offset:36864
    ds_read_b128 v[132:135], v33 offset:36864
    v_mfma_f32_32x32x16_bf16 v[96:111], v[156:159], v[144:147], v[96:111]
    ds_read_b64_tr_b16 v[136:137], v36 offset:51200
    buffer_load_dwordx4 v26, s[40:43], s97 offen offset:1024 sc1 lds
    v_mfma_f32_32x32x16_bf16 v[80:95], v[152:155], v[148:151], v[80:95]
    ds_read_b64_tr_b16 v[138:139], v36 offset:51712
    ds_read_b64_tr_b16 v[140:141], v37 offset:51200
    v_mfma_f32_32x32x16_bf16 v[112:127], v[156:159], v[148:151], v[112:127]
    ds_read_b64_tr_b16 v[142:143], v37 offset:51712
    buffer_load_dwordx4 v27, s[40:43], s97 offen offset:2048 sc1 lds
    s_waitcnt lgkmcnt(6)
    v_mfma_f32_32x32x16_bf16 v[240:255], v[168:171], v[160:163], v[240:255]
    ds_read_b128 v[144:147], v32 offset:40960
    ds_read_b128 v[148:151], v33 offset:40960
    v_mfma_f32_32x32x16_bf16 v[96:111], v[172:175], v[160:163], v[96:111]
    ds_read_b64_tr_b16 v[152:153], v36 offset:53248
    buffer_load_dwordx4 v27, s[40:43], s97 offen offset:3072 sc1 lds
    v_mfma_f32_32x32x16_bf16 v[80:95], v[168:171], v[164:167], v[80:95]
    ds_read_b64_tr_b16 v[154:155], v36 offset:53760
    ds_read_b64_tr_b16 v[156:157], v37 offset:53248
    v_mfma_f32_32x32x16_bf16 v[112:127], v[172:175], v[164:167], v[112:127]
    ds_read_b64_tr_b16 v[158:159], v37 offset:53760
    s_add_u32 m0, s64, 16384
    s_nop 0
    buffer_load_dwordx4 v28, s[56:59], s98 offen offset:0 lds
    s_waitcnt lgkmcnt(6)
    v_mfma_f32_32x32x16_bf16 v[240:255], v[136:139], v[128:131], v[240:255]
    ds_read_b128 v[160:163], v32 offset:45056
    ds_read_b128 v[164:167], v33 offset:45056
    v_mfma_f32_32x32x16_bf16 v[96:111], v[140:143], v[128:131], v[96:111]
    ds_read_b64_tr_b16 v[168:169], v36 offset:55296
    s_add_u32 m0, s64, 24448
    s_nop 0
    buffer_load_dwordx4 v28, s[56:59], s98 offen offset:128 lds
    v_mfma_f32_32x32x16_bf16 v[80:95], v[136:139], v[132:135], v[80:95]
    ds_read_b64_tr_b16 v[170:171], v36 offset:55808
    ds_read_b64_tr_b16 v[172:173], v37 offset:55296
    v_mfma_f32_32x32x16_bf16 v[112:127], v[140:143], v[132:135], v[112:127]
    ds_read_b64_tr_b16 v[174:175], v37 offset:55808
    s_add_u32 m0, s64, 16384
    s_nop 0
    buffer_load_dwordx4 v29, s[56:59], s98 offen offset:1024 lds
    s_waitcnt lgkmcnt(6)
    v_mfma_f32_32x32x16_bf16 v[240:255], v[152:155], v[144:147], v[240:255]
    s_add_u32 m0, s64, 24448
    s_nop 0
    buffer_load_dwordx4 v29, s[56:59], s98 offen offset:1152 lds
    v_mfma_f32_32x32x16_bf16 v[96:111], v[156:159], v[144:147], v[96:111]
    s_waitcnt vmcnt(8) lgkmcnt(0)
    s_barrier
    v_mfma_f32_32x32x16_bf16 v[80:95], v[152:155], v[148:151], v[80:95]
    ds_read_b128 v[128:131], v34 offset:0
    ds_read_b128 v[132:135], v35 offset:0
    ds_read_b64_tr_b16 v[136:137], v38 offset:16384
    ds_read_b64_tr_b16 v[138:139], v38 offset:16896
    v_mfma_f32_32x32x16_bf16 v[112:127], v[156:159], v[148:151], v[112:127]
    ds_read_b64_tr_b16 v[140:141], v39 offset:16384
    ds_read_b64_tr_b16 v[142:143], v39 offset:16896
    s_lshl_b32 s12, s65, 2
    s_add_u32 s12, s12, s66
    s_lshl_b32 s12, s12, 8
    s_add_u32 s12, s12, 11567104
    v_and_b32 v30, 3, v1
    v_lshl_add_u32 v30, v30, 6, s12
    buffer_load_dword v31, v30, s[40:43], 0 offen sc1
    v_mfma_f32_32x32x16_bf16 v[240:255], v[168:171], v[160:163], v[240:255]
    ds_read_b128 v[144:147], v34 offset:4096
    ds_read_b128 v[148:151], v35 offset:4096
    v_mfma_f32_32x32x16_bf16 v[96:111], v[172:175], v[160:163], v[96:111]
    ds_read_b64_tr_b16 v[152:153], v38 offset:18432
    s_add_u32 m0, s64, 106496
    s_add_u32 s97, s33, 0
    buffer_load_dwordx4 v14, s[52:55], s97 offen lds
    v_mfma_f32_32x32x16_bf16 v[80:95], v[168:171], v[164:167], v[80:95]
    ds_read_b64_tr_b16 v[154:155], v38 offset:18944
    ds_read_b64_tr_b16 v[156:157], v39 offset:18432
    v_mfma_f32_32x32x16_bf16 v[112:127], v[172:175], v[164:167], v[112:127]
    ds_read_b64_tr_b16 v[158:159], v39 offset:18944
    buffer_load_dwordx4 v15, s[52:55], s97 offen offset:1024 lds
    s_waitcnt lgkmcnt(6)
    v_mfma_f32_32x32x16_bf16 v[240:255], v[136:139], v[128:131], v[240:255]
    ds_read_b128 v[160:163], v34 offset:8192
    ds_read_b128 v[164:167], v35 offset:8192
    v_mfma_f32_32x32x16_bf16 v[96:111], v[140:143], v[128:131], v[96:111]
    ds_read_b64_tr_b16 v[168:169], v38 offset:20480
    s_add_u32 m0, s64, 114688
    s_add_u32 s97, s33, 16384
    buffer_load_dwordx4 v14, s[52:55], s97 offen lds
    v_mfma_f32_32x32x16_bf16 v[80:95], v[136:139], v[132:135], v[80:95]
    ds_read_b64_tr_b16 v[170:171], v38 offset:20992
    ds_read_b64_tr_b16 v[172:173], v39 offset:20480
    v_mfma_f32_32x32x16_bf16 v[112:127], v[140:143], v[132:135], v[112:127]
    ds_read_b64_tr_b16 v[174:175], v39 offset:20992
    buffer_load_dwordx4 v15, s[52:55], s97 offen offset:1024 lds
    s_waitcnt lgkmcnt(6)
    v_mfma_f32_32x32x16_bf16 v[240:255], v[152:155], v[144:147], v[240:255]
    ds_read_b128 v[128:131], v34 offset:12288
    ds_read_b128 v[132:135], v35 offset:12288
    v_mfma_f32_32x32x16_bf16 v[96:111], v[156:159], v[144:147], v[96:111]
    ds_read_b64_tr_b16 v[136:137], v38 offset:22528
    s_add_u32 m0, s64, 122880
    s_add_u32 s97, s33, 32768
    buffer_load_dwordx4 v14, s[52:55], s97 offen lds
    v_mfma_f32_32x32x16_bf16 v[80:95], v[152:155], v[148:151], v[80:95]
    ds_read_b64_tr_b16 v[138:139], v38 offset:23040
    ds_read_b64_tr_b16 v[140:141], v39 offset:22528
    v_mfma_f32_32x32x16_bf16 v[112:127], v[156:159], v[148:151], v[112:127]
    ds_read_b64_tr_b16 v[142:143], v39 offset:23040
    buffer_load_dwordx4 v15, s[52:55], s97 offen offset:1024 lds
    s_waitcnt lgkmcnt(6)
    v_mfma_f32_32x32x16_bf16 v[240:255], v[168:171], v[160:163], v[240:255]
    s_add_u32 m0, s64, 131072
    s_add_u32 s97, s33, 49152
    buffer_load_dwordx4 v14, s[52:55], s97 offen lds
    v_mfma_f32_32x32x16_bf16 v[96:111], v[172:175], v[160:163], v[96:111]
    buffer_load_dwordx4 v15, s[52:55], s97 offen offset:1024 lds
    s_waitcnt vmcnt(9) lgkmcnt(0)
    s_barrier
    v_mfma_f32_32x32x16_bf16 v[80:95], v[168:171], v[164:167], v[80:95]
    ds_read_b128 v[144:147], v32 offset:0
    ds_read_b128 v[148:151], v33 offset:0
    ds_read_b64_tr_b16 v[152:153], v36 offset:16384
    ds_read_b64_tr_b16 v[154:155], v36 offset:16896
    v_mfma_f32_32x32x16_bf16 v[112:127], v[172:175], v[164:167], v[112:127]
    ds_read_b64_tr_b16 v[156:157], v37 offset:16384
    ds_read_b64_tr_b16 v[158:159], v37 offset:16896
    s_add_u32 m0, s64, 139264
    s_add_u32 s97, s33, 65536
    buffer_load_dwordx4 v14, s[52:55], s97 offen lds
    v_mfma_f32_32x32x16_bf16 v[240:255], v[136:139], v[128:131], v[240:255]
    ds_read_b128 v[160:163], v32 offset:4096
    ds_read_b128 v[164:167], v33 offset:4096
    v_mfma_f32_32x32x16_bf16 v[96:111], v[140:143], v[128:131], v[96:111]
    ds_read_b64_tr_b16 v[168:169], v36 offset:18432
    buffer_load_dwordx4 v15, s[52:55], s97 offen offset:1024 lds
    v_mfma_f32_32x32x16_bf16 v[80:95], v[136:139], v[132:135], v[80:95]
    ds_read_b64_tr_b16 v[170:171], v36 offset:18944
    ds_read_b64_tr_b16 v[172:173], v37 offset:18432
    v_mfma_f32_32x32x16_bf16 v[112:127], v[140:143], v[132:135], v[112:127]
    ds_read_b64_tr_b16 v[174:175], v37 offset:18944
    s_add_u32 m0, s64, 147456
    s_add_u32 s97, s33, 81920
    buffer_load_dwordx4 v14, s[52:55], s97 offen lds
    s_waitcnt lgkmcnt(6)
    v_mfma_f32_32x32x16_bf16 v[240:255], v[152:155], v[144:147], v[240:255]
    ds_read_b128 v[128:131], v32 offset:8192
    ds_read_b128 v[132:135], v33 offset:8192
    v_mfma_f32_32x32x16_bf16 v[96:111], v[156:159], v[144:147], v[96:111]
    ds_read_b64_tr_b16 v[136:137], v36 offset:20480
    buffer_load_dwordx4 v15, s[52:55], s97 offen offset:1024 lds
    v_mfma_f32_32x32x16_bf16 v[80:95], v[152:155], v[148:151], v[80:95]
    ds_read_b64_tr_b16 v[138:139], v36 offset:20992
    ds_read_b64_tr_b16 v[140:141], v37 offset:20480
    v_mfma_f32_32x32x16_bf16 v[112:127], v[156:159], v[148:151], v[112:127]
    ds_read_b64_tr_b16 v[142:143], v37 offset:20992
    s_add_u32 m0, s64, 155648
    s_add_u32 s97, s33, 98304
    buffer_load_dwordx4 v14, s[52:55], s97 offen lds
    s_waitcnt lgkmcnt(6)
    v_mfma_f32_32x32x16_bf16 v[240:255], v[168:171], v[160:163], v[240:255]
    ds_read_b128 v[144:147], v32 offset:12288
    ds_read_b128 v[148:151], v33 offset:12288
    v_mfma_f32_32x32x16_bf16 v[96:111], v[172:175], v[160:163], v[96:111]
    ds_read_b64_tr_b16 v[152:153], v36 offset:22528
    buffer_load_dwordx4 v15, s[52:55], s97 offen offset:1024 lds
    v_mfma_f32_32x32x16_bf16 v[80:95], v[168:171], v[164:167], v[80:95]
    ds_read_b64_tr_b16 v[154:155], v36 offset:23040
    ds_read_b64_tr_b16 v[156:157], v37 offset:22528
    v_mfma_f32_32x32x16_bf16 v[112:127], v[172:175], v[164:167], v[112:127]
    ds_read_b64_tr_b16 v[158:159], v37 offset:23040
    s_add_u32 m0, s64, 98304
    s_add_u32 s97, s33, 114688
    buffer_load_dwordx4 v14, s[52:55], s97 offen lds
    buffer_load_dwordx4 v15, s[52:55], s97 offen offset:1024 lds
    s_waitcnt lgkmcnt(0)
    s_barrier
    s_waitcnt vmcnt(16)
    v_cmp_ne_u32 s[100:101], s96, v31
    s_mov_b32 s99, 0x40000
    s_cmp_eq_u64 s[100:101], 0
    s_cbranch_scc1 L_pd5
L_pl5:
    s_mov_b64 exec, s[100:101]
    buffer_load_dword v31, v30, s[40:43], 0 offen sc1
    s_waitcnt vmcnt(0)
    v_cmp_ne_u32 s[100:101], s96, v31
    s_sub_u32 s99, s99, 1
    s_cselect_b64 s[100:101], 0, s[100:101]
    s_cmp_eq_u64 s[100:101], 0
    s_cbranch_scc0 L_pl5
    s_mov_b64 exec, -1
L_pd5:
    v_mfma_f32_32x32x16_bf16 v[80:95], v[136:139], v[132:135], v[80:95]
    v_mfma_f32_32x32x16_bf16 v[80:95], v[152:155], v[148:151], v[80:95]
    buffer_load_dword v62, v24, s[40:43], 0 offen sc1
    s_add_u32 m0, s64, 32768
    s_add_u32 s97, s19, 0
    buffer_load_dwordx4 v12, s[48:51], s97 offen lds
    buffer_load_dwordx4 v13, s[48:51], s97 offen offset:1024 lds
    s_lshl_b32 s10, s65, 2
    s_add_u32 s10, s10, s66
    s_lshl_b32 s10, s10, 2
    s_lshr_b32 s11, s4, 1
    v_mfma_f32_32x32x16_bf16 v[96:111], v[140:143], v[128:131], v[96:111]
    v_mfma_f32_32x32x16_bf16 v[96:111], v[156:159], v[144:147], v[96:111]
    s_xor_b32 s12, s11, 1
    s_add_u32 s12, s12, s10
    s_mul_i32 s12, s12, 24576
    s_add_u32 s12, s12, s64
    s_add_u32 s12, s12, 16777216
    v_cvt_pk_bf16_f32 v192, v80, v81
    v_cvt_pk_bf16_f32 v193, v82, v83
    v_cvt_pk_bf16_f32 v194, v84, v85
    v_cvt_pk_bf16_f32 v195, v86, v87
    buffer_store_dwordx4 v[192:195], v26, s[40:43], s12 offen offset:0 sc1
    v_cvt_pk_bf16_f32 v196, v88, v89
    v_cvt_pk_bf16_f32 v197, v90, v91
    v_cvt_pk_bf16_f32 v198, v92, v93
    v_cvt_pk_bf16_f32 v199, v94, v95
    buffer_store_dwordx4 v[196:199], v26, s[40:43], s12 offen offset:1024 sc1
    v_mfma_f32_32x32x16_bf16 v[112:127], v[140:143], v[132:135], v[112:127]
    v_mfma_f32_32x32x16_bf16 v[112:127], v[156:159], v[148:151], v[112:127]
    s_xor_b32 s12, s11, 2
    s_add_u32 s12, s12, s10
    s_mul_i32 s12, s12, 24576
    s_add_u32 s12, s12, s64
    s_add_u32 s12, s12, 16785408
    v_cvt_pk_bf16_f32 v200, v96, v97
    v_cvt_pk_bf16_f32 v201, v98, v99
    v_cvt_pk_bf16_f32 v202, v100, v101
    v_cvt_pk_bf16_f32 v203, v102, v103
    buffer_store_dwordx4 v[200:203], v26, s[40:43], s12 offen offset:0 sc1
    v_cvt_pk_bf16_f32 v204, v104, v105
    v_cvt_pk_bf16_f32 v205, v106, v107
    v_cvt_pk_bf16_f32 v206, v108, v109
    v_cvt_pk_bf16_f32 v207, v110, v111
    buffer_store_dwordx4 v[204:207], v26, s[40:43], s12 offen offset:1024 sc1
    v_mfma_f32_32x32x16_bf16 v[240:255], v[136:139], v[128:131], v[240:255]
    v_mfma_f32_32x32x16_bf16 v[240:255], v[152:155], v[144:147], v[240:255]
    s_xor_b32 s12, s11, 3
    s_add_u32 s12, s12, s10
    s_mul_i32 s12, s12, 24576
    s_add_u32 s12, s12, s64
    s_add_u32 s12, s12, 16793600
    v_cvt_pk_bf16_f32 v208, v112, v113
    v_cvt_pk_bf16_f32 v209, v114, v115
    v_cvt_pk_bf16_f32 v210, v116, v117
    v_cvt_pk_bf16_f32 v211, v118, v119
    buffer_store_dwordx4 v[208:211], v26, s[40:43], s12 offen offset:0 sc1
    v_cvt_pk_bf16_f32 v212, v120, v121
    v_cvt_pk_bf16_f32 v213, v122, v123
    v_cvt_pk_bf16_f32 v214, v124, v125
    v_cvt_pk_bf16_f32 v215, v126, v127
    buffer_store_dwordx4 v[212:215], v26, s[40:43], s12 offen offset:1024 sc1
    s_add_u32 s12, s10, s11
    s_mul_i32 s67, s12, 24576
    s_add_u32 s67, s67, s64
    s_add_u32 s67, s67, 16777216
    s_mov_b32 s70, 1
    s_branch L_p2
L_red:
    s_sub_u32 s8, s5, 22
    s_lshl_b32 s8, s8, 3
    s_add_u32 s8, s8, s4
    v_lshlrev_b32 v4, 4, v1
    s_lshl_b32 s10, s8, 2
    s_add_u32 s10, s10, s3
    s_mul_i32 s10, s10, 12288
    s_add_u32 s10, s10, 8388608
    v_and_b32 v6, 3, v1
    v_mul_u32_u24 v6, 3072, v6
    s_add_u32 s11, s10, 3068
    v_add_u32 v30, s11, v6
    buffer_load_dword v31, v30, s[40:43], 0 offen sc1
    s_waitcnt vmcnt(0)
    v_cmp_ne_u32 s[100:101], s96, v31
    s_mov_b32 s99, 0x40000
    s_cmp_eq_u64 s[100:101], 0
    s_cbranch_scc1 L_pd6
L_pl6:
    s_mov_b64 exec, s[100:101]
    buffer_load_dword v31, v30, s[40:43], 0 offen sc1
    s_waitcnt vmcnt(0)
    v_cmp_ne_u32 s[100:101], s96, v31
    s_sub_u32 s99, s99, 1
    s_cselect_b64 s[100:101], 0, s[100:101]
    s_cmp_eq_u64 s[100:101], 0
    s_cbranch_scc0 L_pl6
    s_mov_b64 exec, -1
L_pd6:
    s_add_u32 s12, s10, 0
    buffer_load_dwordx4 v[64:67], v4, s[40:43], s12 offen offset:0 sc1
    buffer_load_dwordx4 v[68:71], v4, s[40:43], s12 offen offset:1024 sc1
    buffer_load_dwordx4 v[72:75], v4, s[40:43], s12 offen offset:2048 sc1
    s_add_u32 s12, s10, 3072
    buffer_load_dwordx4 v[76:79], v4, s[40:43], s12 offen offset:0 sc1
    buffer_load_dwordx4 v[80:83], v4, s[40:43], s12 offen offset:1024 sc1
    buffer_load_dwordx4 v[84:87], v4, s[40:43], s12 offen offset:2048 sc1
    s_add_u32 s12, s10, 6144
    buffer_load_dwordx4 v[88:91], v4, s[40:43], s12 offen offset:0 sc1
    buffer_load_dwordx4 v[92:95], v4, s[40:43], s12 offen offset:1024 sc1
    buffer_load_dwordx4 v[96:99], v4, s[40:43], s12 offen offset:2048 sc1
    s_add_u32 s12, s10, 9216
    buffer_load_dwordx4 v[100:103], v4, s[40:43], s12 offen offset:0 sc1
    buffer_load_dwordx4 v[104:107], v4, s[40:43], s12 offen offset:1024 sc1
    buffer_load_dwordx4 v[108:111], v4, s[40:43], s12 offen offset:2048 sc1
    s_mul_i32 s12, s3, 3072
    v_add_u32 v5, s12, v4
    s_and_b32 s9, s3, 1
    s_lshr_b32 s7, s3, 1
    v_lshrrev_b32 v6, 5, v1
    v_lshlrev_b32 v6, 4, v6
    s_lshl_b32 s12, s9, 6
    s_lshl_b32 s13, s7, 5
    s_add_u32 s12, s12, s13
    s_add_u32 s12, s12, 12288
    v_add_u32 v6, s12, v6
    v_and_b32 v7, 31, v1
    v_lshlrev_b32 v7, 2, v7
    s_waitcnt vmcnt(0)
    s_mov_b32 s99, 0x8000
    s_branch L_tc7
L_tl7:
    s_add_u32 s12, s10, 0
    buffer_load_dwordx4 v[64:67], v4, s[40:43], s12 offen offset:0 sc1
    buffer_load_dwordx4 v[68:71], v4, s[40:43], s12 offen offset:1024 sc1
    buffer_load_dwordx4 v[72:75], v4, s[40:43], s12 offen offset:2048 sc1
    s_add_u32 s12, s10, 3072
    buffer_load_dwordx4 v[76:79], v4, s[40:43], s12 offen offset:0 sc1
    buffer_load_dwordx4 v[80:83], v4, s[40:43], s12 offen offset:1024 sc1
    buffer_load_dwordx4 v[84:87], v4, s[40:43], s12 offen offset:2048 sc1
    s_add_u32 s12, s10, 6144
    buffer_load_dwordx4 v[88:91], v4, s[40:43], s12 offen offset:0 sc1
    buffer_load_dwordx4 v[92:95], v4, s[40:43], s12 offen offset:1024 sc1
    buffer_load_dwordx4 v[96:99], v4, s[40:43], s12 offen offset:2048 sc1
    s_add_u32 s12, s10, 9216
    buffer_load_dwordx4 v[100:103], v4, s[40:43], s12 offen offset:0 sc1
    buffer_load_dwordx4 v[104:107], v4, s[40:43], s12 offen offset:1024 sc1
    buffer_load_dwordx4 v[108:111], v4, s[40:43], s12 offen offset:2048 sc1
    s_waitcnt vmcnt(0)
L_tc7:
    v_min3_u32 v2, v67, v71, v75
    v_max3_u32 v3, v67, v71, v75
    v_min3_u32 v2, v2, v79, v83
    v_max3_u32 v3, v3, v79, v83
    v_min3_u32 v2, v2, v87, v91
    v_max3_u32 v3, v3, v87, v91
    v_min3_u32 v2, v2, v95, v99
    v_max3_u32 v3, v3, v95, v99
    v_min3_u32 v2, v2, v103, v107
    v_max3_u32 v3, v3, v103, v107
    v_min3_u32 v2, v2, v111, v111
    v_max3_u32 v3, v3, v111, v111
    v_xor_b32 v2, s96, v2
    v_xor_b32 v3, s96, v3
    v_or_b32 v2, v2, v3
    v_cmp_ne_u32 s[100:101], 0, v2
    s_sub_u32 s99, s99, 1
    s_cselect_b64 s[100:101], 0, s[100:101]
    s_cmp_eq_u64 s[100:101], 0
    s_cbranch_scc0 L_tl7
    v_pk_add_f32 v[64:65], v[64:65], v[76:77]
    v_add_f32 v66, v66, v78
    v_pk_add_f32 v[68:69], v[68:69], v[80:81]
    v_add_f32 v70, v70, v82
    v_pk_add_f32 v[72:73], v[72:73], v[84:85]
    v_add_f32 v74, v74, v86
    v_pk_add_f32 v[64:65], v[64:65], v[88:89]
    v_add_f32 v66, v66, v90
    v_pk_add_f32 v[68:69], v[68:69], v[92:93]
    v_add_f32 v70, v70, v94
    v_pk_add_f32 v[72:73], v[72:73], v[96:97]
    v_add_f32 v74, v74, v98
    v_pk_add_f32 v[64:65], v[64:65], v[100:101]
    v_add_f32 v66, v66, v102
    v_pk_add_f32 v[68:69], v[68:69], v[104:105]
    v_add_f32 v70, v70, v106
    v_pk_add_f32 v[72:73], v[72:73], v[108:109]
    v_add_f32 v74, v74, v110
    ds_write_b128 v5, v[64:67] offset:0
    ds_write_b128 v5, v[68:71] offset:1024
    ds_write_b128 v5, v[72:75] offset:2048
    s_waitcnt lgkmcnt(0)
    s_barrier
    ds_read_b128 v[128:131], v4 offset:0
    ds_read_b128 v[132:135], v4 offset:1024
    ds_read_b128 v[136:139], v4 offset:2048
    ds_read_b128 v[140:143], v4 offset:3072
    ds_read_b128 v[144:147], v4 offset:4096
    ds_read_b128 v[148:151], v4 offset:5120
    ds_read_b128 v[152:155], v4 offset:6144
    ds_read_b128 v[156:159], v4 offset:7168
    ds_read_b128 v[160:163], v4 offset:8192
    ds_read_b128 v[164:167], v4 offset:9216
    ds_read_b128 v[168:171], v4 offset:10240
    ds_read_b128 v[172:175], v4 offset:11264
    s_waitcnt lgkmcnt(0)
    v_pk_add_f32 v[128:129], v[128:129], v[140:141]
    v_add_f32 v130, v130, v142
    v_pk_add_f32 v[132:133], v[132:133], v[144:145]
    v_add_f32 v134, v134, v146
    v_pk_add_f32 v[136:137], v[136:137], v[148:149]
    v_add_f32 v138, v138, v150
    v_pk_add_f32 v[128:129], v[128:129], v[152:153]
    v_add_f32 v130, v130, v154
    v_pk_add_f32 v[132:133], v[132:133], v[156:157]
    v_add_f32 v134, v134, v158
    v_pk_add_f32 v[136:137], v[136:137], v[160:161]
    v_add_f32 v138, v138, v162
    v_pk_add_f32 v[128:129], v[128:129], v[164:165]
    v_add_f32 v130, v130, v166
    v_pk_add_f32 v[132:133], v[132:133], v[168:169]
    v_add_f32 v134, v134, v170
    v_pk_add_f32 v[136:137], v[136:137], v[172:173]
    v_add_f32 v138, v138, v174
    ds_write_b32 v7, v138 offset:12288
    s_cmp_eq_u32 s7, 0
    s_cselect_b64 vcc, -1, 0
    v_cndmask_b32 v72, v133, v128, vcc
    v_cndmask_b32 v73, v134, v129, vcc
    v_cndmask_b32 v74, v136, v130, vcc
    v_cndmask_b32 v75, v137, v132, vcc
    s_waitcnt lgkmcnt(0)
    ds_read_b128 v[80:83], v6
    v_bfe_u32 v2, v1, 4, 1
    v_cmp_eq_u32 vcc, s9, v2
    s_lshl_b32 s12, s8, 1
    s_add_u32 s12, s12, s9
    s_lshl_b32 s71, s12, 1
    s_add_u32 s71, s71, s7
    s_lshl_b32 s71, s71, 6
    s_add_u32 s71, s71, 11714560
    s_lshl_b32 s12, s12, 10
    s_lshl_b32 s13, s7, 3
    s_add_u32 s12, s12, s13
    s_add_u32 s12, s12, 4194304
    s_waitcnt lgkmcnt(0)
    v_cndmask_b32 v72, v80, v72, vcc
    v_cndmask_b32 v73, v81, v73, vcc
    v_cndmask_b32 v74, v82, v74, vcc
    v_cndmask_b32 v75, v83, v75, vcc
    v_cvt_pk_bf16_f32 v76, v72, v73
    v_cvt_pk_bf16_f32 v77, v74, v75
    buffer_store_dwordx2 v[76:77], v4, s[40:43], s12 offen sc1
    s_waitcnt vmcnt(0)
    v_mov_b32 v2, s96
    v_mov_b32 v3, 0
    s_mov_b64 exec, 1
    buffer_store_dword v2, v3, s[40:43], s71 offen sc1
    s_mov_b64 exec, -1
    s_barrier
    s_mov_b32 s60, s30
    s_mov_b32 s61, s31
    s_mov_b32 s62, 4096
    s_mov_b32 s63, 0x20000
    s_lshl_b32 s14, s16, 7
    v_and_b32 v2, 31, v1
    v_lshlrev_b32 v2, 1, v2
    buffer_load_ushort v46, v2, s[60:63], s14 offen
    buffer_load_ushort v47, v2, s[60:63], s14 offen offset:64
    buffer_load_dword v62, v24, s[40:43], 0 offen sc1
    buffer_load_dwordx2 v[56:57], v22, s[40:43], 0 offen sc1
    buffer_load_dwordx2 v[58:59], v23, s[40:43], 0 offen sc1
    s_add_u32 m0, s64, 106496
    s_add_u32 s97, s33, 0
    buffer_load_dwordx4 v14, s[52:55], s97 offen lds
    buffer_load_dwordx4 v15, s[52:55], s97 offen offset:1024 lds
    s_add_u32 m0, s64, 114688
    s_add_u32 s97, s33, 16384
    buffer_load_dwordx4 v14, s[52:55], s97 offen lds
    buffer_load_dwordx4 v15, s[52:55], s97 offen offset:1024 lds
    s_add_u32 m0, s64, 122880
    s_add_u32 s97, s33, 32768
    buffer_load_dwordx4 v14, s[52:55], s97 offen lds
    buffer_load_dwordx4 v15, s[52:55], s97 offen offset:1024 lds
    s_add_u32 m0, s64, 131072
    s_add_u32 s97, s33, 49152
    buffer_load_dwordx4 v14, s[52:55], s97 offen lds
    buffer_load_dwordx4 v15, s[52:55], s97 offen offset:1024 lds
    s_add_u32 m0, s64, 139264
    s_add_u32 s97, s33, 65536
    buffer_load_dwordx4 v14, s[52:55], s97 offen lds
    buffer_load_dwordx4 v15, s[52:55], s97 offen offset:1024 lds
    s_add_u32 m0, s64, 147456
    s_add_u32 s97, s33, 81920
    buffer_load_dwordx4 v14, s[52:55], s97 offen lds
    buffer_load_dwordx4 v15, s[52:55], s97 offen offset:1024 lds
    s_add_u32 m0, s64, 155648
    s_add_u32 s97, s33, 98304
    buffer_load_dwordx4 v14, s[52:55], s97 offen lds
    buffer_load_dwordx4 v15, s[52:55], s97 offen offset:1024 lds
    s_add_u32 m0, s64, 98304
    s_add_u32 s97, s33, 114688
    buffer_load_dwordx4 v14, s[52:55], s97 offen lds
    buffer_load_dwordx4 v15, s[52:55], s97 offen offset:1024 lds
    s_add_u32 m0, s64, 32768
    s_add_u32 s97, s19, 0
    buffer_load_dwordx4 v12, s[48:51], s97 offen lds
    buffer_load_dwordx4 v13, s[48:51], s97 offen offset:1024 lds
    s_lshl_b32 s71, s2, 2
    s_add_u32 s71, s71, s3
    s_lshl_b32 s71, s71, 6
    s_add_u32 s71, s71, 11730944
    s_mov_b32 s70, 0
    s_waitcnt vmcnt(0) lgkmcnt(0)
    s_branch L_p2
L_p2:
    s_waitcnt vmcnt(6)
    v_cmp_ne_u32 s[100:101], s96, v62
    s_mov_b32 s99, 0x40000
    s_cmp_eq_u64 s[100:101], 0
    s_cbranch_scc1 L_pd8
L_pl8:
    s_mov_b64 exec, s[100:101]
    buffer_load_dword v62, v24, s[40:43], 0 offen sc1
    s_waitcnt vmcnt(0)
    v_cmp_ne_u32 s[100:101], s96, v62
    s_sub_u32 s99, s99, 1
    s_cselect_b64 s[100:101], 0, s[100:101]
    s_cmp_eq_u64 s[100:101], 0
    s_cbranch_scc0 L_pl8
    s_mov_b64 exec, -1
L_pd8:
    s_add_u32 s98, s32, 0
    buffer_load_dwordx4 a[0:3], v10, s[40:43], s98 offen sc1
    buffer_load_dwordx4 a[4:7], v11, s[40:43], s98 offen sc1
    s_add_u32 s98, s32, 1024
    buffer_load_dwordx4 a[8:11], v10, s[40:43], s98 offen sc1
    buffer_load_dwordx4 a[12:15], v11, s[40:43], s98 offen sc1
    s_add_u32 s98, s32, 2048
    buffer_load_dwordx4 a[16:19], v10, s[40:43], s98 offen sc1
    buffer_load_dwordx4 a[20:23], v11, s[40:43], s98 offen sc1
    s_add_u32 s98, s32, 3072
    buffer_load_dwordx4 a[24:27], v10, s[40:43], s98 offen sc1
    buffer_load_dwordx4 a[28:31], v11, s[40:43], s98 offen sc1
    s_add_u32 s98, s32, 4096
    buffer_load_dwordx4 a[32:35], v10, s[40:43], s98 offen sc1
    buffer_load_dwordx4 a[36:39], v11, s[40:43], s98 offen sc1
    s_add_u32 s98, s32, 5120
    buffer_load_dwordx4 a[40:43], v10, s[40:43], s98 offen sc1
    buffer_load_dwordx4 a[44:47], v11, s[40:43], s98 offen sc1
    s_add_u32 s98, s32, 6144
    buffer_load_dwordx4 a[48:51], v10, s[40:43], s98 offen sc1
    buffer_load_dwordx4 a[52:55], v11, s[40:43], s98 offen sc1
    s_add_u32 s98, s32, 7168
    buffer_load_dwordx4 a[56:59], v10, s[40:43], s98 offen sc1
    buffer_load_dwordx4 a[60:63], v11, s[40:43], s98 offen sc1
    ds_read_b64_tr_b16 a[64:65], v18 offset:40960
    ds_read_b64_tr_b16 a[66:67], v18 offset:41984
    ds_read_b64_tr_b16 a[68:69], v19 offset:40960
    ds_read_b64_tr_b16 a[70:71], v19 offset:41984
    ds_read_b64_tr_b16 a[72:73], v18 offset:49152
    ds_read_b64_tr_b16 a[74:75], v18 offset:50176
    ds_read_b64_tr_b16 a[76:77], v19 offset:49152
    ds_read_b64_tr_b16 a[78:79], v19 offset:50176
    ds_read_b64_tr_b16 a[80:81], v18 offset:57344
    ds_read_b64_tr_b16 a[82:83], v18 offset:58368
    ds_read_b64_tr_b16 a[84:85], v19 offset:57344
    ds_read_b64_tr_b16 a[86:87], v19 offset:58368
    s_waitcnt lgkmcnt(4)
    ds_read_b64_tr_b16 a[88:89], v20 offset:0
    ds_read_b64_tr_b16 a[90:91], v20 offset:1024
    ds_read_b64_tr_b16 a[92:93], v21 offset:0
    ds_read_b64_tr_b16 a[94:95], v21 offset:1024
    ds_read_b64_tr_b16 a[96:97], v20 offset:8192
    ds_read_b64_tr_b16 a[98:99], v20 offset:9216
    ds_read_b64_tr_b16 a[100:101], v21 offset:8192
    ds_read_b64_tr_b16 a[102:103], v21 offset:9216
    ds_read_b64_tr_b16 a[104:105], v20 offset:16384
    ds_read_b64_tr_b16 a[106:107], v20 offset:17408
    ds_read_b64_tr_b16 a[108:109], v21 offset:16384
    ds_read_b64_tr_b16 a[110:111], v21 offset:17408
    s_waitcnt lgkmcnt(4)
    ds_read_b64_tr_b16 a[112:113], v20 offset:24576
    ds_read_b64_tr_b16 a[114:115], v20 offset:25600
    ds_read_b64_tr_b16 a[116:117], v21 offset:24576
    ds_read_b64_tr_b16 a[118:119], v21 offset:25600
    ds_read_b64_tr_b16 a[120:121], v18 offset:32768
    ds_read_b64_tr_b16 a[122:123], v18 offset:33792
    ds_read_b64_tr_b16 a[124:125], v19 offset:32768
    ds_read_b64_tr_b16 a[126:127], v19 offset:33792
    v_cmp_ne_u32 s[100:101], s96, v56
    s_mov_b32 s99, 0x40000
    s_cmp_eq_u64 s[100:101], 0
    s_cbranch_scc1 L_pd9
L_pl9:
    s_mov_b64 exec, s[100:101]
    buffer_load_dwordx2 v[56:57], v22, s[40:43], 0 offen sc1
    s_waitcnt vmcnt(0)
    v_cmp_ne_u32 s[100:101], s96, v56
    s_sub_u32 s99, s99, 1
    s_cselect_b64 s[100:101], 0, s[100:101]
    s_cmp_eq_u64 s[100:101], 0
    s_cbranch_scc0 L_pl9
    s_mov_b64 exec, -1
L_pd9:
    v_cmp_ne_u32 s[100:101], s96, v58
    s_mov_b32 s99, 0x40000
    s_cmp_eq_u64 s[100:101], 0
    s_cbranch_scc1 L_pd10
L_pl10:
    s_mov_b64 exec, s[100:101]
    buffer_load_dwordx2 v[58:59], v23, s[40:43], 0 offen sc1
    s_waitcnt vmcnt(0)
    v_cmp_ne_u32 s[100:101], s96, v58
    s_sub_u32 s99, s99, 1
    s_cselect_b64 s[100:101], 0, s[100:101]
    s_cmp_eq_u64 s[100:101], 0
    s_cbranch_scc0 L_pl10
    s_mov_b64 exec, -1
L_pd10:
    s_mov_b32 s56, s34
    s_mov_b32 s57, s35
    s_mov_b32 s58, 2097152
    s_mov_b32 s59, 0x20000
    s_cmp_lt_u32 s3, 2
    s_cselect_b64 vcc, -1, 0
    v_cndmask_b32 v56, v59, v57, vcc
    v_cndmask_b32 v58, v47, v46, vcc
    v_bfe_u32 v46, v1, 3, 1
    v_bfe_u32 v2, v1, 5, 1
    v_lshl_add_u32 v29, v2, 1, v46
    v_bfe_u32 v3, v1, 4, 1
    v_lshl_add_u32 v27, v3, 2, v29
    s_and_b32 s12, s3, 1
    s_lshl_b32 s14, s12, 4
    v_add_u32 v27, s14, v27
    v_add_f32 v56, 1.0, v56
    v_lshlrev_b32 v2, 2, v27
    v_rcp_f32 v56, v56
    v_lshlrev_b32 v58, 16, v58
    s_lshr_b32 s14, s3, 1
    s_lshl_b32 s15, s14, 13
    s_lshl_b32 s12, s12, 11
    s_add_u32 s15, s15, s12
    v_lshlrev_b32 v29, 8, v29
    v_lshl_add_u32 v29, v3, 7, v29
    v_and_b32 v3, 3, v1
    v_lshl_add_u32 v29, v3, 5, v29
    v_lshl_add_u32 v29, v46, 4, v29
    v_bfe_u32 v46, v1, 2, 1
    v_lshl_add_u32 v29, v46, 12, v29
    v_add_u32 v29, s15, v29
    v_mul_f32 v58, v58, v56
    ds_bpermute_b32 v22, v2, v56 offset:32
    ds_bpermute_b32 v23, v2, v58 offset:32
    ds_bpermute_b32 v56, v2, v56
    ds_bpermute_b32 v58, v2, v58
    s_lshl_b32 s14, s14, 5
    s_lshl_b32 s15, s16, 6
    s_add_u32 s14, s14, s15
    v_add_u32 v27, s14, v27
    v_lshlrev_b32 v27, 10, v27
    v_and_b32 v3, 7, v1
    v_lshl_add_u32 v27, v3, 4, v27
    v_and_b32 v28, 31, v1
    s_waitcnt lgkmcnt(0)
    s_cmp_eq_u32 s70, 1
    s_cbranch_scc1 L_ublk
    v_and_b32 v60, 15, v1
    s_lshl_b32 s14, s3, 10
    s_add_u32 s14, s14, 11714560
    v_lshl_add_u32 v60, v60, 6, s14
    buffer_load_dword v61, v60, s[40:43], 0 offen sc1
    s_add_u32 m0, s64, 40960
    s_add_u32 s97, s19, 65536
    buffer_load_dwordx4 v12, s[48:51], s97 offen lds
    buffer_load_dwordx4 v13, s[48:51], s97 offen offset:1024 lds
    s_add_u32 m0, s64, 49152
    s_add_u32 s97, s19, 131072
    buffer_load_dwordx4 v12, s[48:51], s97 offen lds
    buffer_load_dwordx4 v13, s[48:51], s97 offen offset:1024 lds
    s_add_u32 m0, s64, 57344
    s_add_u32 s97, s19, 196608
    buffer_load_dwordx4 v12, s[48:51], s97 offen lds
    buffer_load_dwordx4 v13, s[48:51], s97 offen offset:1024 lds
    s_waitcnt vmcnt(0)
    s_cmp_eq_u32 s2, 255
    s_cbranch_scc0 L_y
    v_lshlrev_b32 v30, 6, v1
    v_add_u32 v30, 11567104, v30
    buffer_load_dword v31, v30, s[40:43], 0 offen sc1
    s_waitcnt vmcnt(0)
    v_cmp_ne_u32 s[100:101], s96, v31
    s_mov_b32 s99, 0x40000
    s_cmp_eq_u64 s[100:101], 0
    s_cbranch_scc1 L_pd11
L_pl11:
    s_mov_b64 exec, s[100:101]
    buffer_load_dword v31, v30, s[40:43], 0 offen sc1
    s_waitcnt vmcnt(0)
    v_cmp_ne_u32 s[100:101], s96, v31
    s_sub_u32 s99, s99, 1
    s_cselect_b64 s[100:101], 0, s[100:101]
    s_cmp_eq_u64 s[100:101], 0
    s_cbranch_scc0 L_pl11
    s_mov_b64 exec, -1
L_pd11:
    s_branch L_y
L_ublk:
    s_waitcnt vmcnt(16)
    s_add_u32 s12, s67, 0
    buffer_load_dwordx4 v[64:67], v10, s[40:43], s12 offen offset:0 sc1
    buffer_load_dwordx4 v[68:71], v10, s[40:43], s12 offen offset:1024 sc1
    s_add_u32 s12, s67, 8192
    buffer_load_dwordx4 v[72:75], v10, s[40:43], s12 offen offset:0 sc1
    buffer_load_dwordx4 v[76:79], v10, s[40:43], s12 offen offset:1024 sc1
    s_add_u32 s12, s67, 16384
    buffer_load_dwordx4 v[80:83], v10, s[40:43], s12 offen offset:0 sc1
    buffer_load_dwordx4 v[84:87], v10, s[40:43], s12 offen offset:1024 sc1
    v_and_b32 v60, 15, v1
    s_lshl_b32 s14, s3, 10
    s_add_u32 s14, s14, 11714560
    v_lshl_add_u32 v60, v60, 6, s14
    buffer_load_dword v61, v60, s[40:43], 0 offen sc1
    s_add_u32 m0, s64, 40960
    s_add_u32 s97, s19, 65536
    buffer_load_dwordx4 v12, s[48:51], s97 offen lds
    buffer_load_dwordx4 v13, s[48:51], s97 offen offset:1024 lds
    s_add_u32 m0, s64, 49152
    s_add_u32 s97, s19, 131072
    buffer_load_dwordx4 v12, s[48:51], s97 offen lds
    buffer_load_dwordx4 v13, s[48:51], s97 offen offset:1024 lds
    s_add_u32 m0, s64, 57344
    s_add_u32 s97, s19, 196608
    buffer_load_dwordx4 v12, s[48:51], s97 offen lds
    buffer_load_dwordx4 v13, s[48:51], s97 offen offset:1024 lds
    s_mov_b32 s8, 0xbdd2d3e8
    s_mov_b32 s9, s8
    v_mov_b32 v2, 0xc0135761
    v_mov_b32 v4, 0x3f80
    v_mov_b32 v5, 0x3f800000
    s_lshl_b32 s13, s65, 2
    s_and_b32 s11, s3, 2
    s_add_u32 s13, s13, s11
    s_lshr_b32 s11, s4, 2
    s_add_u32 s13, s13, s11
    s_lshl_b32 s10, s66, 1
    s_and_b32 s11, s3, 1
    s_add_u32 s10, s10, s11
    s_bfe_u32 s14, s4, 0x10001
    s_lshl_b32 s71, s13, 1
    s_add_u32 s71, s71, s14
    s_lshl_b32 s11, s10, 7
    s_add_u32 s71, s71, s11
    s_lshl_b32 s71, s71, 6
    s_add_u32 s71, s71, 11649024
    s_lshl_b32 s13, s13, 15
    s_lshl_b32 s10, s10, 10
    s_add_u32 s13, s13, s10
    s_lshl_b32 s14, s14, 9
    s_add_u32 s13, s13, s14
    s_add_u32 s14, s13, 16384
    v_lshrrev_b32 v6, 5, v1
    v_lshlrev_b32 v6, 13, v6
    v_lshl_add_u32 v6, v28, 4, v6
    s_waitcnt vmcnt(7)
    s_mov_b32 s99, 0x8000
    s_branch L_tc12
L_tl12:
    s_add_u32 s12, s67, 0
    buffer_load_dwordx4 v[64:67], v10, s[40:43], s12 offen offset:0 sc1
    buffer_load_dwordx4 v[68:71], v10, s[40:43], s12 offen offset:1024 sc1
    s_add_u32 s12, s67, 8192
    buffer_load_dwordx4 v[72:75], v10, s[40:43], s12 offen offset:0 sc1
    buffer_load_dwordx4 v[76:79], v10, s[40:43], s12 offen offset:1024 sc1
    s_add_u32 s12, s67, 16384
    buffer_load_dwordx4 v[80:83], v10, s[40:43], s12 offen offset:0 sc1
    buffer_load_dwordx4 v[84:87], v10, s[40:43], s12 offen offset:1024 sc1
    s_waitcnt vmcnt(0)
L_tc12:
    v_max3_u32 v63, v64, v68, v72
    v_max3_u32 v63, v63, v76, v80
    v_max3_u32 v63, v63, v84, v84
    v_cmp_eq_u32 s[100:101], -1, v63
    s_sub_u32 s99, s99, 1
    s_cselect_b64 s[100:101], 0, s[100:101]
    s_cmp_eq_u64 s[100:101], 0
    s_cbranch_scc0 L_tl12
    v_dot2c_f32_bf16 v240, v64, v4
    v_dot2c_f32_bf16 v241, v64, v5
    v_dot2c_f32_bf16 v242, v65, v4
    v_dot2c_f32_bf16 v243, v65, v5
    v_dot2c_f32_bf16 v244, v66, v4
    v_dot2c_f32_bf16 v245, v66, v5
    v_dot2c_f32_bf16 v246, v67, v4
    v_dot2c_f32_bf16 v247, v67, v5
    v_dot2c_f32_bf16 v248, v68, v4
    v_dot2c_f32_bf16 v249, v68, v5
    v_dot2c_f32_bf16 v250, v69, v4
    v_dot2c_f32_bf16 v251, v69, v5
    v_dot2c_f32_bf16 v252, v70, v4
    v_dot2c_f32_bf16 v253, v70, v5
    v_dot2c_f32_bf16 v254, v71, v4
    v_dot2c_f32_bf16 v255, v71, v5
    v_dot2c_f32_bf16 v240, v72, v4
    v_dot2c_f32_bf16 v241, v72, v5
    v_dot2c_f32_bf16 v242, v73, v4
    v_dot2c_f32_bf16 v243, v73, v5
    v_dot2c_f32_bf16 v244, v74, v4
    v_dot2c_f32_bf16 v245, v74, v5
    v_dot2c_f32_bf16 v246, v75, v4
    v_dot2c_f32_bf16 v247, v75, v5
    v_dot2c_f32_bf16 v248, v76, v4
    v_dot2c_f32_bf16 v249, v76, v5
    v_dot2c_f32_bf16 v250, v77, v4
    v_dot2c_f32_bf16 v251, v77, v5
    v_dot2c_f32_bf16 v252, v78, v4
    v_dot2c_f32_bf16 v253, v78, v5
    v_dot2c_f32_bf16 v254, v79, v4
    v_dot2c_f32_bf16 v255, v79, v5
    v_dot2c_f32_bf16 v240, v80, v4
    v_dot2c_f32_bf16 v241, v80, v5
    v_dot2c_f32_bf16 v242, v81, v4
    v_dot2c_f32_bf16 v243, v81, v5
    v_dot2c_f32_bf16 v244, v82, v4
    v_dot2c_f32_bf16 v245, v82, v5
    v_dot2c_f32_bf16 v246, v83, v4
    v_dot2c_f32_bf16 v247, v83, v5
    v_dot2c_f32_bf16 v248, v84, v4
    v_dot2c_f32_bf16 v249, v84, v5
    v_dot2c_f32_bf16 v250, v85, v4
    v_dot2c_f32_bf16 v251, v85, v5
    v_dot2c_f32_bf16 v252, v86, v4
    v_dot2c_f32_bf16 v253, v86, v5
    v_dot2c_f32_bf16 v254, v87, v4
    v_dot2c_f32_bf16 v255, v87, v5
    s_nop 2
    v_pk_mul_f32 v[104:105], v[240:241], v[240:241]
    v_pk_mul_f32 v[106:107], v[242:243], v[242:243]
    v_pk_mul_f32 v[108:109], v[244:245], v[244:245]
    v_pk_mul_f32 v[110:111], v[246:247], v[246:247]
    v_pk_fma_f32 v[104:105], v[104:105], s[8:9], v[2:3] op_sel_hi:[1,1,0]
    v_pk_fma_f32 v[106:107], v[106:107], s[8:9], v[2:3] op_sel_hi:[1,1,0]
    v_pk_fma_f32 v[108:109], v[108:109], s[8:9], v[2:3] op_sel_hi:[1,1,0]
    v_pk_fma_f32 v[110:111], v[110:111], s[8:9], v[2:3] op_sel_hi:[1,1,0]
    v_pk_mul_f32 v[104:105], v[104:105], v[240:241]
    v_pk_mul_f32 v[106:107], v[106:107], v[242:243]
    v_pk_mul_f32 v[108:109], v[108:109], v[244:245]
    v_pk_mul_f32 v[110:111], v[110:111], v[246:247]
    v_exp_f32 v104, v104
    v_exp_f32 v105, v105
    v_exp_f32 v106, v106
    v_exp_f32 v107, v107
    v_exp_f32 v108, v108
    v_exp_f32 v109, v109
    v_exp_f32 v110, v110
    v_exp_f32 v111, v111
    v_pk_add_f32 v[104:105], v[104:105], 1.0 op_sel_hi:[1,0]
    v_pk_add_f32 v[106:107], v[106:107], 1.0 op_sel_hi:[1,0]
    v_pk_add_f32 v[108:109], v[108:109], 1.0 op_sel_hi:[1,0]
    v_pk_add_f32 v[110:111], v[110:111], 1.0 op_sel_hi:[1,0]
    v_rcp_f32 v104, v104
    v_rcp_f32 v105, v105
    v_rcp_f32 v106, v106
    v_rcp_f32 v107, v107
    v_rcp_f32 v108, v108
    v_rcp_f32 v109, v109
    v_rcp_f32 v110, v110
    v_rcp_f32 v111, v111
    v_pk_mul_f32 v[104:105], v[104:105], v[240:241]
    v_pk_mul_f32 v[106:107], v[106:107], v[242:243]
    v_pk_mul_f32 v[108:109], v[108:109], v[244:245]
    v_pk_mul_f32 v[110:111], v[110:111], v[246:247]
    v_cvt_pk_bf16_f32 v240, v104, v105
    v_cvt_pk_bf16_f32 v241, v106, v107
    v_cvt_pk_bf16_f32 v242, v108, v109
    v_cvt_pk_bf16_f32 v243, v110, v111
    v_pk_mul_f32 v[112:113], v[248:249], v[248:249]
    v_pk_mul_f32 v[114:115], v[250:251], v[250:251]
    v_pk_mul_f32 v[116:117], v[252:253], v[252:253]
    v_pk_mul_f32 v[118:119], v[254:255], v[254:255]
    v_pk_fma_f32 v[112:113], v[112:113], s[8:9], v[2:3] op_sel_hi:[1,1,0]
    v_pk_fma_f32 v[114:115], v[114:115], s[8:9], v[2:3] op_sel_hi:[1,1,0]
    v_pk_fma_f32 v[116:117], v[116:117], s[8:9], v[2:3] op_sel_hi:[1,1,0]
    v_pk_fma_f32 v[118:119], v[118:119], s[8:9], v[2:3] op_sel_hi:[1,1,0]
    v_pk_mul_f32 v[112:113], v[112:113], v[248:249]
    v_pk_mul_f32 v[114:115], v[114:115], v[250:251]
    v_pk_mul_f32 v[116:117], v[116:117], v[252:253]
    v_pk_mul_f32 v[118:119], v[118:119], v[254:255]
    v_exp_f32 v112, v112
    v_exp_f32 v113, v113
    v_exp_f32 v114, v114
    v_exp_f32 v115, v115
    v_exp_f32 v116, v116
    v_exp_f32 v117, v117
    v_exp_f32 v118, v118
    v_exp_f32 v119, v119
    v_pk_add_f32 v[112:113], v[112:113], 1.0 op_sel_hi:[1,0]
    v_pk_add_f32 v[114:115], v[114:115], 1.0 op_sel_hi:[1,0]
    v_pk_add_f32 v[116:117], v[116:117], 1.0 op_sel_hi:[1,0]
    v_pk_add_f32 v[118:119], v[118:119], 1.0 op_sel_hi:[1,0]
    v_rcp_f32 v112, v112
    v_rcp_f32 v113, v113
    v_rcp_f32 v114, v114
    v_rcp_f32 v115, v115
    v_rcp_f32 v116, v116
    v_rcp_f32 v117, v117
    v_rcp_f32 v118, v118
    v_rcp_f32 v119, v119
    v_pk_mul_f32 v[112:113], v[112:113], v[248:249]
    v_pk_mul_f32 v[114:115], v[114:115], v[250:251]
    v_pk_mul_f32 v[116:117], v[116:117], v[252:253]
    v_pk_mul_f32 v[118:119], v[118:119], v[254:255]
    v_cvt_pk_bf16_f32 v244, v112, v113
    v_cvt_pk_bf16_f32 v245, v114, v115
    v_cvt_pk_bf16_f32 v246, v116, v117
    v_cvt_pk_bf16_f32 v247, v118, v119
    buffer_store_dwordx4 v[240:243], v6, s[44:47], s13 offen sc1
    buffer_store_dwordx4 v[244:247], v6, s[44:47], s14 offen sc1
L_y:
    s_waitcnt vmcnt(2)
    v_cmp_ne_u32 s[100:101], s96, v61
    s_mov_b32 s99, 0x40000
    s_cmp_eq_u64 s[100:101], 0
    s_cbranch_scc1 L_pd13
    s_waitcnt vmcnt(0)
    v_mov_b32 v2, s96
    v_mov_b32 v3, 0
    s_mov_b64 exec, 1
    buffer_store_dword v2, v3, s[40:43], s71 offen sc1
    s_mov_b64 exec, -1
L_pl13:
    s_mov_b64 exec, s[100:101]
    buffer_load_dword v61, v60, s[40:43], 0 offen sc1
    s_waitcnt vmcnt(0)
    v_cmp_ne_u32 s[100:101], s96, v61
    s_sub_u32 s99, s99, 1
    s_cselect_b64 s[100:101], 0, s[100:101]
    s_cmp_eq_u64 s[100:101], 0
    s_cbranch_scc0 L_pl13
    s_mov_b64 exec, -1
L_pd13:
    s_add_u32 s15, s36, 0
    buffer_load_dwordx4 v[192:195], v10, s[40:43], s15 offen offset:0 sc1
    buffer_load_dwordx4 v[196:199], v10, s[40:43], s15 offen offset:1024 sc1
    buffer_load_dwordx4 v[200:203], v10, s[40:43], s15 offen offset:2048 sc1
    buffer_load_dwordx4 v[204:207], v10, s[40:43], s15 offen offset:3072 sc1
    s_add_u32 s15, s36, 4096
    buffer_load_dwordx4 v[208:211], v10, s[40:43], s15 offen offset:0 sc1
    buffer_load_dwordx4 v[212:215], v10, s[40:43], s15 offen offset:1024 sc1
    buffer_load_dwordx4 v[216:219], v10, s[40:43], s15 offen offset:2048 sc1
    buffer_load_dwordx4 v[220:223], v10, s[40:43], s15 offen offset:3072 sc1
    v_mov_b32 v60, v57
    v_mov_b32 v61, v59
    s_mov_b32 s13, 0x358637bd
    s_lshl_b32 s10, s16, 6
    s_waitcnt vmcnt(8)
    v_mov_b32 v2, s96
    v_mov_b32 v3, 0
    s_mov_b64 exec, 1
    buffer_store_dword v2, v3, s[40:43], s71 offen sc1
    s_mov_b64 exec, -1
    s_waitcnt vmcnt(8)
    v_mfma_f32_32x32x16_bf16 v[64:79], v[192:195], a[0:3], 0
    v_mfma_f32_32x32x16_bf16 v[80:95], v[192:195], a[4:7], 0
    s_waitcnt vmcnt(7)
    v_mfma_f32_32x32x16_bf16 v[96:111], v[196:199], a[8:11], 0
    v_mfma_f32_32x32x16_bf16 v[112:127], v[196:199], a[12:15], 0
    s_nop 7
    v_add_f32 v72, s13, v72
    v_add_f32 v88, s13, v88
    v_rcp_f32 v72, v72
    v_rcp_f32 v88, v88
    v_mul_f32 v72, v72, v60
    v_mul_f32 v88, v88, v61
    v_mul_f32 v64, v64, v72
    v_mul_f32 v80, v80, v88
    v_mul_f32 v65, v65, v72
    v_mul_f32 v81, v81, v88
    v_mul_f32 v66, v66, v72
    v_mul_f32 v82, v82, v88
    v_mul_f32 v67, v67, v72
    v_mul_f32 v83, v83, v88
    v_mul_f32 v68, v68, v72
    v_mul_f32 v84, v84, v88
    v_mul_f32 v69, v69, v72
    v_mul_f32 v85, v85, v88
    v_mul_f32 v70, v70, v72
    v_mul_f32 v86, v86, v88
    v_mul_f32 v71, v71, v72
    v_mul_f32 v87, v87, v88
    v_cvt_pk_bf16_f32 v224, v64, v65
    v_cvt_pk_bf16_f32 v228, v80, v81
    v_cvt_pk_bf16_f32 v225, v66, v67
    v_cvt_pk_bf16_f32 v229, v82, v83
    v_cvt_pk_bf16_f32 v226, v68, v69
    v_cvt_pk_bf16_f32 v230, v84, v85
    v_cvt_pk_bf16_f32 v227, v70, v71
    v_cvt_pk_bf16_f32 v231, v86, v87
    s_nop 0
    v_mfma_f32_32x32x16_bf16 v[128:143], v[224:227], a[64:67], 0
    v_add_f32 v96, s13, v96
    v_add_f32 v112, s13, v112
    v_rcp_f32 v96, v96
    v_rcp_f32 v112, v112
    v_mul_f32 v96, v96, v60
    s_add_u32 m0, s64, 73728
    s_add_u32 s97, s19, 262144
    buffer_load_dwordx4 v12, s[48:51], s97 offen lds
    v_mfma_f32_32x32x16_bf16 v[160:175], v[228:231], a[64:67], 0
    v_mul_f32 v112, v112, v61
    v_mul_f32 v104, v104, v96
    v_mul_f32 v120, v120, v112
    v_mul_f32 v105, v105, v96
    v_mul_f32 v121, v121, v112
    buffer_load_dwordx4 v13, s[48:51], s97 offen offset:1024 lds
    v_mfma_f32_32x32x16_bf16 v[144:159], v[224:227], a[68:71], 0
    v_mul_f32 v106, v106, v96
    v_mul_f32 v122, v122, v112
    v_mul_f32 v107, v107, v96
    v_mul_f32 v123, v123, v112
    v_mul_f32 v108, v108, v96
    s_add_u32 m0, s64, 81920
    s_add_u32 s97, s19, 327680
    buffer_load_dwordx4 v12, s[48:51], s97 offen lds
    v_mfma_f32_32x32x16_bf16 v[176:191], v[228:231], a[68:71], 0
    v_mul_f32 v124, v124, v112
    v_mul_f32 v109, v109, v96
    v_mul_f32 v125, v125, v112
    v_mul_f32 v110, v110, v96
    v_mul_f32 v126, v126, v112
    buffer_load_dwordx4 v13, s[48:51], s97 offen offset:1024 lds
    s_waitcnt vmcnt(10)
    v_mfma_f32_32x32x16_bf16 v[64:79], v[200:203], a[16:19], 0
    v_mul_f32 v111, v111, v96
    v_mul_f32 v127, v127, v112
    v_cvt_pk_bf16_f32 v232, v104, v105
    v_cvt_pk_bf16_f32 v236, v120, v121
    v_cvt_pk_bf16_f32 v233, v106, v107
    s_add_u32 m0, s64, 65536
    s_add_u32 s97, s19, 393216
    buffer_load_dwordx4 v12, s[48:51], s97 offen lds
    v_mfma_f32_32x32x16_bf16 v[80:95], v[200:203], a[20:23], 0
    v_cvt_pk_bf16_f32 v237, v122, v123
    v_cvt_pk_bf16_f32 v234, v108, v109
    v_cvt_pk_bf16_f32 v238, v124, v125
    v_cvt_pk_bf16_f32 v235, v110, v111
    v_cvt_pk_bf16_f32 v239, v126, v127
    buffer_load_dwordx4 v13, s[48:51], s97 offen offset:1024 lds
    v_mfma_f32_32x32x16_bf16 v[128:143], v[232:235], a[72:75], v[128:143]
    v_add_f32 v72, s13, v72
    s_nop 3
    v_add_f32 v88, s13, v88
    v_rcp_f32 v72, v72
    v_rcp_f32 v88, v88
    v_mul_f32 v72, v72, v60
    s_add_u32 m0, s64, 90112
    s_add_u32 s97, s19, 458752
    buffer_load_dwordx4 v12, s[48:51], s97 offen lds
    v_mfma_f32_32x32x16_bf16 v[160:175], v[236:239], a[72:75], v[160:175]
    v_mul_f32 v88, v88, v61
    v_mul_f32 v64, v64, v72
    v_mul_f32 v80, v80, v88
    v_mul_f32 v65, v65, v72
    v_mul_f32 v81, v81, v88
    buffer_load_dwordx4 v13, s[48:51], s97 offen offset:1024 lds
    v_mfma_f32_32x32x16_bf16 v[144:159], v[232:235], a[76:79], v[144:159]
    v_mul_f32 v66, v66, v72
    v_mul_f32 v82, v82, v88
    v_mul_f32 v67, v67, v72
    v_mul_f32 v83, v83, v88
    v_mul_f32 v68, v68, v72
    s_add_u32 m0, s64, 0
    s_add_u32 s97, s19, 524288
    buffer_load_dwordx4 v12, s[48:51], s97 offen lds
    v_mfma_f32_32x32x16_bf16 v[176:191], v[236:239], a[76:79], v[176:191]
    v_mul_f32 v84, v84, v88
    v_mul_f32 v69, v69, v72
    v_mul_f32 v85, v85, v88
    v_mul_f32 v70, v70, v72
    v_mul_f32 v86, v86, v88
    buffer_load_dwordx4 v13, s[48:51], s97 offen offset:1024 lds
    s_waitcnt vmcnt(15)
    v_mfma_f32_32x32x16_bf16 v[96:111], v[204:207], a[24:27], 0
    v_mul_f32 v71, v71, v72
    v_mul_f32 v87, v87, v88
    v_cvt_pk_bf16_f32 v224, v64, v65
    v_cvt_pk_bf16_f32 v228, v80, v81
    v_cvt_pk_bf16_f32 v225, v66, v67
    s_add_u32 m0, s64, 8192
    s_add_u32 s97, s19, 589824
    buffer_load_dwordx4 v12, s[48:51], s97 offen lds
    v_mfma_f32_32x32x16_bf16 v[112:127], v[204:207], a[28:31], 0
    v_cvt_pk_bf16_f32 v229, v82, v83
    v_cvt_pk_bf16_f32 v226, v68, v69
    v_cvt_pk_bf16_f32 v230, v84, v85
    v_cvt_pk_bf16_f32 v227, v70, v71
    v_cvt_pk_bf16_f32 v231, v86, v87
    buffer_load_dwordx4 v13, s[48:51], s97 offen offset:1024 lds
    v_mfma_f32_32x32x16_bf16 v[128:143], v[224:227], a[80:83], v[128:143]
    v_add_f32 v96, s13, v96
    s_nop 3
    v_add_f32 v112, s13, v112
    v_rcp_f32 v96, v96
    v_rcp_f32 v112, v112
    v_mul_f32 v96, v96, v60
    s_add_u32 m0, s64, 16384
    s_add_u32 s97, s19, 655360
    buffer_load_dwordx4 v12, s[48:51], s97 offen lds
    v_mfma_f32_32x32x16_bf16 v[160:175], v[228:231], a[80:83], v[160:175]
    v_mul_f32 v112, v112, v61
    v_mul_f32 v104, v104, v96
    v_mul_f32 v120, v120, v112
    v_mul_f32 v105, v105, v96
    v_mul_f32 v121, v121, v112
    buffer_load_dwordx4 v13, s[48:51], s97 offen offset:1024 lds
    v_mfma_f32_32x32x16_bf16 v[144:159], v[224:227], a[84:87], v[144:159]
    v_mul_f32 v106, v106, v96
    v_mul_f32 v122, v122, v112
    v_mul_f32 v107, v107, v96
    v_mul_f32 v123, v123, v112
    v_mul_f32 v108, v108, v96
    s_add_u32 m0, s64, 24576
    s_add_u32 s97, s19, 720896
    buffer_load_dwordx4 v12, s[48:51], s97 offen lds
    v_mfma_f32_32x32x16_bf16 v[176:191], v[228:231], a[84:87], v[176:191]
    v_mul_f32 v124, v124, v112
    v_mul_f32 v109, v109, v96
    v_mul_f32 v125, v125, v112
    v_mul_f32 v110, v110, v96
    v_mul_f32 v126, v126, v112
    buffer_load_dwordx4 v13, s[48:51], s97 offen offset:1024 lds
    s_waitcnt vmcnt(20)
    v_mfma_f32_32x32x16_bf16 v[64:79], v[208:211], a[32:35], 0
    v_mul_f32 v111, v111, v96
    v_mul_f32 v127, v127, v112
    v_cvt_pk_bf16_f32 v232, v104, v105
    v_cvt_pk_bf16_f32 v236, v120, v121
    v_cvt_pk_bf16_f32 v233, v106, v107
    s_add_u32 m0, s64, 98304
    s_add_u32 s97, s19, 786432
    buffer_load_dwordx4 v12, s[48:51], s97 offen lds
    v_mfma_f32_32x32x16_bf16 v[80:95], v[208:211], a[36:39], 0
    v_cvt_pk_bf16_f32 v237, v122, v123
    v_cvt_pk_bf16_f32 v234, v108, v109
    v_cvt_pk_bf16_f32 v238, v124, v125
    v_cvt_pk_bf16_f32 v235, v110, v111
    v_cvt_pk_bf16_f32 v239, v126, v127
    buffer_load_dwordx4 v13, s[48:51], s97 offen offset:1024 lds
    v_mfma_f32_32x32x16_bf16 v[128:143], v[232:235], a[88:91], v[128:143]
    v_add_f32 v72, s13, v72
    s_nop 3
    v_add_f32 v88, s13, v88
    v_rcp_f32 v72, v72
    v_rcp_f32 v88, v88
    v_mul_f32 v72, v72, v60
    s_add_u32 m0, s64, 106496
    s_add_u32 s97, s19, 851968
    buffer_load_dwordx4 v12, s[48:51], s97 offen lds
    v_mfma_f32_32x32x16_bf16 v[160:175], v[236:239], a[88:91], v[160:175]
    v_mul_f32 v88, v88, v61
    v_mul_f32 v64, v64, v72
    v_mul_f32 v80, v80, v88
    v_mul_f32 v65, v65, v72
    v_mul_f32 v81, v81, v88
    buffer_load_dwordx4 v13, s[48:51], s97 offen offset:1024 lds
    v_mfma_f32_32x32x16_bf16 v[144:159], v[232:235], a[92:95], v[144:159]
    v_mul_f32 v66, v66, v72
    v_mul_f32 v82, v82, v88
    v_mul_f32 v67, v67, v72
    v_mul_f32 v83, v83, v88
    v_mul_f32 v68, v68, v72
    s_add_u32 m0, s64, 114688
    s_add_u32 s97, s19, 917504
    buffer_load_dwordx4 v12, s[48:51], s97 offen lds
    v_mfma_f32_32x32x16_bf16 v[176:191], v[236:239], a[92:95], v[176:191]
    v_mul_f32 v84, v84, v88
    v_mul_f32 v69, v69, v72
    v_mul_f32 v85, v85, v88
    v_mul_f32 v70, v70, v72
    v_mul_f32 v86, v86, v88
    buffer_load_dwordx4 v13, s[48:51], s97 offen offset:1024 lds
    s_waitcnt vmcnt(25)
    v_mfma_f32_32x32x16_bf16 v[96:111], v[212:215], a[40:43], 0
    v_mul_f32 v71, v71, v72
    v_mul_f32 v87, v87, v88
    v_cvt_pk_bf16_f32 v224, v64, v65
    v_cvt_pk_bf16_f32 v228, v80, v81
    v_cvt_pk_bf16_f32 v225, v66, v67
    s_add_u32 m0, s64, 122880
    s_add_u32 s97, s19, 983040
    buffer_load_dwordx4 v12, s[48:51], s97 offen lds
    v_mfma_f32_32x32x16_bf16 v[112:127], v[212:215], a[44:47], 0
    v_cvt_pk_bf16_f32 v229, v82, v83
    v_cvt_pk_bf16_f32 v226, v68, v69
    v_cvt_pk_bf16_f32 v230, v84, v85
    v_cvt_pk_bf16_f32 v227, v70, v71
    v_cvt_pk_bf16_f32 v231, v86, v87
    buffer_load_dwordx4 v13, s[48:51], s97 offen offset:1024 lds
    v_mfma_f32_32x32x16_bf16 v[128:143], v[224:227], a[96:99], v[128:143]
    v_add_f32 v96, s13, v96
    s_nop 3
    v_add_f32 v112, s13, v112
    v_rcp_f32 v96, v96
    v_rcp_f32 v112, v112
    v_mul_f32 v96, v96, v60
    s_add_u32 m0, s64, 131072
    s_add_u32 s97, s19, 1048576
    buffer_load_dwordx4 v12, s[48:51], s97 offen lds
    v_mfma_f32_32x32x16_bf16 v[160:175], v[228:231], a[96:99], v[160:175]
    v_mul_f32 v112, v112, v61
    v_mul_f32 v104, v104, v96
    v_mul_f32 v120, v120, v112
    v_mul_f32 v105, v105, v96
    v_mul_f32 v121, v121, v112
    buffer_load_dwordx4 v13, s[48:51], s97 offen offset:1024 lds
    v_mfma_f32_32x32x16_bf16 v[144:159], v[224:227], a[100:103], v[144:159]
    v_mul_f32 v106, v106, v96
    v_mul_f32 v122, v122, v112
    v_mul_f32 v107, v107, v96
    v_mul_f32 v123, v123, v112
    v_mul_f32 v108, v108, v96
    s_add_u32 m0, s64, 139264
    s_add_u32 s97, s19, 1114112
    buffer_load_dwordx4 v12, s[48:51], s97 offen lds
    v_mfma_f32_32x32x16_bf16 v[176:191], v[228:231], a[100:103], v[176:191]
    v_mul_f32 v124, v124, v112
    v_mul_f32 v109, v109, v96
    v_mul_f32 v125, v125, v112
    v_mul_f32 v110, v110, v96
    v_mul_f32 v126, v126, v112
    buffer_load_dwordx4 v13, s[48:51], s97 offen offset:1024 lds
    s_waitcnt vmcnt(30)
    v_mfma_f32_32x32x16_bf16 v[64:79], v[216:219], a[48:51], 0
    v_mul_f32 v111, v111, v96
    v_mul_f32 v127, v127, v112
    v_cvt_pk_bf16_f32 v232, v104, v105
    v_cvt_pk_bf16_f32 v236, v120, v121
    v_cvt_pk_bf16_f32 v233, v106, v107
    s_add_u32 m0, s64, 147456
    s_add_u32 s97, s19, 1179648
    buffer_load_dwordx4 v12, s[48:51], s97 offen lds
    v_mfma_f32_32x32x16_bf16 v[80:95], v[216:219], a[52:55], 0
    v_cvt_pk_bf16_f32 v237, v122, v123
    v_cvt_pk_bf16_f32 v234, v108, v109
    v_cvt_pk_bf16_f32 v238, v124, v125
    v_cvt_pk_bf16_f32 v235, v110, v111
    v_cvt_pk_bf16_f32 v239, v126, v127
    buffer_load_dwordx4 v13, s[48:51], s97 offen offset:1024 lds
    v_mfma_f32_32x32x16_bf16 v[128:143], v[232:235], a[104:107], v[128:143]
    v_add_f32 v72, s13, v72
    s_nop 3
    v_add_f32 v88, s13, v88
    v_rcp_f32 v72, v72
    v_rcp_f32 v88, v88
    v_mul_f32 v72, v72, v60
    v_mul_f32 v88, v88, v61
    v_mfma_f32_32x32x16_bf16 v[160:175], v[236:239], a[104:107], v[160:175]
    v_mul_f32 v64, v64, v72
    v_mul_f32 v80, v80, v88
    v_mul_f32 v65, v65, v72
    v_mul_f32 v81, v81, v88
    s_add_u32 m0, s64, 155648
    s_add_u32 s97, s19, 1245184
    buffer_load_dwordx4 v12, s[48:51], s97 offen lds
    v_mfma_f32_32x32x16_bf16 v[144:159], v[232:235], a[108:111], v[144:159]
    v_mul_f32 v66, v66, v72
    v_mul_f32 v82, v82, v88
    v_mul_f32 v67, v67, v72
    v_mul_f32 v83, v83, v88
    v_mul_f32 v68, v68, v72
    v_mul_f32 v84, v84, v88
    v_mfma_f32_32x32x16_bf16 v[176:191], v[236:239], a[108:111], v[176:191]
    v_mul_f32 v69, v69, v72
    v_mul_f32 v85, v85, v88
    v_mul_f32 v70, v70, v72
    v_mul_f32 v86, v86, v88
    buffer_load_dwordx4 v13, s[48:51], s97 offen offset:1024 lds
    s_waitcnt vmcnt(33)
    v_mfma_f32_32x32x16_bf16 v[96:111], v[220:223], a[56:59], 0
    v_mul_f32 v71, v71, v72
    v_mul_f32 v87, v87, v88
    v_cvt_pk_bf16_f32 v224, v64, v65
    v_cvt_pk_bf16_f32 v228, v80, v81
    v_cvt_pk_bf16_f32 v225, v66, v67
    v_cvt_pk_bf16_f32 v229, v82, v83
    v_mfma_f32_32x32x16_bf16 v[112:127], v[220:223], a[60:63], 0
    v_cvt_pk_bf16_f32 v226, v68, v69
    v_cvt_pk_bf16_f32 v230, v84, v85
    v_cvt_pk_bf16_f32 v227, v70, v71
    v_cvt_pk_bf16_f32 v231, v86, v87
    buffer_load_dword v31, v25, s[40:43], 0 offen sc1
    s_waitcnt vmcnt(0)
    v_cmp_ne_u32 s[100:101], s96, v31
    s_mov_b32 s99, 0x40000
    s_cmp_eq_u64 s[100:101], 0
    s_cbranch_scc1 L_pd14
L_pl14:
    s_mov_b64 exec, s[100:101]
    buffer_load_dword v31, v25, s[40:43], 0 offen sc1
    s_waitcnt vmcnt(0)
    v_cmp_ne_u32 s[100:101], s96, v31
    s_sub_u32 s99, s99, 1
    s_cselect_b64 s[100:101], 0, s[100:101]
    s_cmp_eq_u64 s[100:101], 0
    s_cbranch_scc0 L_pl14
    s_mov_b64 exec, -1
L_pd14:
    v_mfma_f32_32x32x16_bf16 v[128:143], v[224:227], a[112:115], v[128:143]
    v_add_f32 v96, s13, v96
    v_add_f32 v112, s13, v112
    v_rcp_f32 v96, v96
    s_add_u32 s98, s18, 0
    buffer_load_dwordx4 a[128:131], v8, s[44:47], s98 offen sc1
    v_rcp_f32 v112, v112
    v_mul_f32 v96, v96, v60
    buffer_load_dwordx4 a[132:135], v9, s[44:47], s98 offen sc1
    v_mul_f32 v112, v112, v61
    v_mul_f32 v104, v104, v96
    s_add_u32 s98, s18, 16384
    buffer_load_dwordx4 a[136:139], v8, s[44:47], s98 offen sc1
    v_mul_f32 v120, v120, v112
    v_mfma_f32_32x32x16_bf16 v[160:175], v[228:231], a[112:115], v[160:175]
    v_mul_f32 v105, v105, v96
    buffer_load_dwordx4 a[140:143], v9, s[44:47], s98 offen sc1
    v_mul_f32 v121, v121, v112
    v_mul_f32 v106, v106, v96
    s_add_u32 s98, s18, 32768
    buffer_load_dwordx4 a[144:147], v8, s[44:47], s98 offen sc1
    v_mul_f32 v122, v122, v112
    v_mul_f32 v107, v107, v96
    buffer_load_dwordx4 a[148:151], v9, s[44:47], s98 offen sc1
    v_mul_f32 v123, v123, v112
    v_mul_f32 v108, v108, v96
    ds_read_b64_tr_b16 v[32:33], v16 offset:32768
    v_mfma_f32_32x32x16_bf16 v[144:159], v[224:227], a[116:119], v[144:159]
    v_mul_f32 v124, v124, v112
    v_mul_f32 v109, v109, v96
    v_mul_f32 v125, v125, v112
    ds_read_b64_tr_b16 v[34:35], v16 offset:33792
    v_mul_f32 v110, v110, v96
    v_mul_f32 v126, v126, v112
    ds_read_b64_tr_b16 v[36:37], v17 offset:32768
    v_mul_f32 v111, v111, v96
    v_mul_f32 v127, v127, v112
    ds_read_b64_tr_b16 v[38:39], v17 offset:33792
    v_cvt_pk_bf16_f32 v232, v104, v105
    v_mfma_f32_32x32x16_bf16 v[176:191], v[228:231], a[116:119], v[176:191]
    v_cvt_pk_bf16_f32 v236, v120, v121
    ds_read_b64_tr_b16 v[40:41], v16 offset:40960
    v_cvt_pk_bf16_f32 v233, v106, v107
    v_cvt_pk_bf16_f32 v237, v122, v123
    ds_read_b64_tr_b16 v[42:43], v16 offset:41984
    v_cvt_pk_bf16_f32 v234, v108, v109
    v_cvt_pk_bf16_f32 v238, v124, v125
    ds_read_b64_tr_b16 v[44:45], v17 offset:40960
    v_cvt_pk_bf16_f32 v235, v110, v111
    v_cvt_pk_bf16_f32 v239, v126, v127
    ds_read_b64_tr_b16 v[46:47], v17 offset:41984
    v_mfma_f32_32x32x16_bf16 v[128:143], v[232:235], a[120:123], v[128:143]
    s_add_u32 s98, s18, 49152
    buffer_load_dwordx4 a[152:155], v8, s[44:47], s98 offen sc1
    buffer_load_dwordx4 a[156:159], v9, s[44:47], s98 offen sc1
    v_mfma_f32_32x32x16_bf16 v[160:175], v[236:239], a[120:123], v[160:175]
    s_add_u32 s98, s18, 65536
    buffer_load_dwordx4 a[160:163], v8, s[44:47], s98 offen sc1
    v_mfma_f32_32x32x16_bf16 v[144:159], v[232:235], a[124:127], v[144:159]
    buffer_load_dwordx4 a[164:167], v9, s[44:47], s98 offen sc1
    s_add_u32 s98, s18, 81920
    buffer_load_dwordx4 a[168:171], v8, s[44:47], s98 offen sc1
    v_mfma_f32_32x32x16_bf16 v[176:191], v[236:239], a[124:127], v[176:191]
    buffer_load_dwordx4 a[172:175], v9, s[44:47], s98 offen sc1
    s_waitcnt vmcnt(10) lgkmcnt(4)
    v_mfma_f32_32x32x16_bf16 v[128:143], v[32:35], a[128:131], v[128:143]
    ds_read_b64_tr_b16 v[48:49], v16 offset:49152
    ds_read_b64_tr_b16 v[50:51], v16 offset:50176
    v_mfma_f32_32x32x16_bf16 v[144:159], v[32:35], a[132:135], v[144:159]
    s_add_u32 s98, s18, 98304
    buffer_load_dwordx4 a[176:179], v8, s[44:47], s98 offen sc1
    v_mfma_f32_32x32x16_bf16 v[160:175], v[36:39], a[128:131], v[160:175]
    ds_read_b64_tr_b16 v[52:53], v17 offset:49152
    ds_read_b64_tr_b16 v[54:55], v17 offset:50176
    v_mfma_f32_32x32x16_bf16 v[176:191], v[36:39], a[132:135], v[176:191]
    buffer_load_dwordx4 a[180:183], v9, s[44:47], s98 offen sc1
    s_waitcnt vmcnt(10) lgkmcnt(4)
    v_mfma_f32_32x32x16_bf16 v[128:143], v[40:43], a[136:139], v[128:143]
    ds_read_b64_tr_b16 v[32:33], v16 offset:57344
    ds_read_b64_tr_b16 v[34:35], v16 offset:58368
    v_mfma_f32_32x32x16_bf16 v[144:159], v[40:43], a[140:143], v[144:159]
    s_add_u32 s98, s18, 114688
    buffer_load_dwordx4 a[184:187], v8, s[44:47], s98 offen sc1
    v_mfma_f32_32x32x16_bf16 v[160:175], v[44:47], a[136:139], v[160:175]
    ds_read_b64_tr_b16 v[36:37], v17 offset:57344
    ds_read_b64_tr_b16 v[38:39], v17 offset:58368
    v_mfma_f32_32x32x16_bf16 v[176:191], v[44:47], a[140:143], v[176:191]
    buffer_load_dwordx4 a[188:191], v9, s[44:47], s98 offen sc1
    s_waitcnt vmcnt(10) lgkmcnt(4)
    v_mfma_f32_32x32x16_bf16 v[128:143], v[48:51], a[144:147], v[128:143]
    ds_read_b64_tr_b16 v[40:41], v18 offset:8192
    ds_read_b64_tr_b16 v[42:43], v18 offset:9216
    v_mfma_f32_32x32x16_bf16 v[144:159], v[48:51], a[148:151], v[144:159]
    s_add_u32 s98, s18, 131072
    buffer_load_dwordx4 a[192:195], v8, s[44:47], s98 offen sc1
    v_mfma_f32_32x32x16_bf16 v[160:175], v[52:55], a[144:147], v[160:175]
    ds_read_b64_tr_b16 v[44:45], v19 offset:8192
    ds_read_b64_tr_b16 v[46:47], v19 offset:9216
    v_mfma_f32_32x32x16_bf16 v[176:191], v[52:55], a[148:151], v[176:191]
    buffer_load_dwordx4 a[196:199], v9, s[44:47], s98 offen sc1
    s_waitcnt vmcnt(10) lgkmcnt(4)
    v_mfma_f32_32x32x16_bf16 v[128:143], v[32:35], a[152:155], v[128:143]
    ds_read_b64_tr_b16 v[48:49], v18 offset:16384
    ds_read_b64_tr_b16 v[50:51], v18 offset:17408
    v_mfma_f32_32x32x16_bf16 v[144:159], v[32:35], a[156:159], v[144:159]
    s_add_u32 s98, s18, 147456
    buffer_load_dwordx4 a[200:203], v8, s[44:47], s98 offen sc1
    v_mfma_f32_32x32x16_bf16 v[160:175], v[36:39], a[152:155], v[160:175]
    ds_read_b64_tr_b16 v[52:53], v19 offset:16384
    ds_read_b64_tr_b16 v[54:55], v19 offset:17408
    v_mfma_f32_32x32x16_bf16 v[176:191], v[36:39], a[156:159], v[176:191]
    buffer_load_dwordx4 a[204:207], v9, s[44:47], s98 offen sc1
    s_waitcnt vmcnt(10) lgkmcnt(4)
    v_mfma_f32_32x32x16_bf16 v[128:143], v[40:43], a[160:163], v[128:143]
    ds_read_b64_tr_b16 v[32:33], v18 offset:0
    ds_read_b64_tr_b16 v[34:35], v18 offset:1024
    v_mfma_f32_32x32x16_bf16 v[144:159], v[40:43], a[164:167], v[144:159]
    s_add_u32 s98, s18, 163840
    buffer_load_dwordx4 a[208:211], v8, s[44:47], s98 offen sc1
    v_mfma_f32_32x32x16_bf16 v[160:175], v[44:47], a[160:163], v[160:175]
    ds_read_b64_tr_b16 v[36:37], v19 offset:0
    ds_read_b64_tr_b16 v[38:39], v19 offset:1024
    v_mfma_f32_32x32x16_bf16 v[176:191], v[44:47], a[164:167], v[176:191]
    buffer_load_dwordx4 a[212:215], v9, s[44:47], s98 offen sc1
    s_waitcnt vmcnt(10) lgkmcnt(4)
    v_mfma_f32_32x32x16_bf16 v[128:143], v[48:51], a[168:171], v[128:143]
    ds_read_b64_tr_b16 v[40:41], v18 offset:24576
    ds_read_b64_tr_b16 v[42:43], v18 offset:25600
    v_mfma_f32_32x32x16_bf16 v[144:159], v[48:51], a[172:175], v[144:159]
    s_add_u32 s98, s18, 180224
    buffer_load_dwordx4 a[216:219], v8, s[44:47], s98 offen sc1
    v_mfma_f32_32x32x16_bf16 v[160:175], v[52:55], a[168:171], v[160:175]
    ds_read_b64_tr_b16 v[44:45], v19 offset:24576
    ds_read_b64_tr_b16 v[46:47], v19 offset:25600
    v_mfma_f32_32x32x16_bf16 v[176:191], v[52:55], a[172:175], v[176:191]
    buffer_load_dwordx4 a[220:223], v9, s[44:47], s98 offen sc1
    s_waitcnt vmcnt(10) lgkmcnt(4)
    v_mfma_f32_32x32x16_bf16 v[128:143], v[32:35], a[176:179], v[128:143]
    ds_read_b64_tr_b16 v[48:49], v16 offset:0
    ds_read_b64_tr_b16 v[50:51], v16 offset:1024
    v_mfma_f32_32x32x16_bf16 v[144:159], v[32:35], a[180:183], v[144:159]
    s_add_u32 s98, s18, 196608
    buffer_load_dwordx4 a[224:227], v8, s[44:47], s98 offen sc1
    v_mfma_f32_32x32x16_bf16 v[160:175], v[36:39], a[176:179], v[160:175]
    ds_read_b64_tr_b16 v[52:53], v17 offset:0
    ds_read_b64_tr_b16 v[54:55], v17 offset:1024
    v_mfma_f32_32x32x16_bf16 v[176:191], v[36:39], a[180:183], v[176:191]
    buffer_load_dwordx4 a[228:231], v9, s[44:47], s98 offen sc1
    s_waitcnt vmcnt(10) lgkmcnt(4)
    v_mfma_f32_32x32x16_bf16 v[128:143], v[40:43], a[184:187], v[128:143]
    ds_read_b64_tr_b16 v[32:33], v16 offset:8192
    s_add_u32 s98, s18, 212992
    buffer_load_dwordx4 a[232:235], v8, s[44:47], s98 offen sc1
    v_mfma_f32_32x32x16_bf16 v[144:159], v[40:43], a[188:191], v[144:159]
    ds_read_b64_tr_b16 v[34:35], v16 offset:9216
    buffer_load_dwordx4 a[236:239], v9, s[44:47], s98 offen sc1
    v_mfma_f32_32x32x16_bf16 v[160:175], v[44:47], a[184:187], v[160:175]
    ds_read_b64_tr_b16 v[36:37], v17 offset:8192
    s_add_u32 m0, s64, 73728
    s_add_u32 s97, s19, 1310720
    buffer_load_dwordx4 v12, s[48:51], s97 offen lds
    v_mfma_f32_32x32x16_bf16 v[176:191], v[44:47], a[188:191], v[176:191]
    ds_read_b64_tr_b16 v[38:39], v17 offset:9216
    buffer_load_dwordx4 v13, s[48:51], s97 offen offset:1024 lds
    s_waitcnt vmcnt(12) lgkmcnt(4)
    v_mfma_f32_32x32x16_bf16 v[128:143], v[48:51], a[192:195], v[128:143]
    ds_read_b64_tr_b16 v[40:41], v16 offset:16384
    s_add_u32 s98, s18, 229376
    buffer_load_dwordx4 a[240:243], v8, s[44:47], s98 offen sc1
    v_mfma_f32_32x32x16_bf16 v[144:159], v[48:51], a[196:199], v[144:159]
    ds_read_b64_tr_b16 v[42:43], v16 offset:17408
    buffer_load_dwordx4 a[244:247], v9, s[44:47], s98 offen sc1
    v_mfma_f32_32x32x16_bf16 v[160:175], v[52:55], a[192:195], v[160:175]
    ds_read_b64_tr_b16 v[44:45], v17 offset:16384
    s_add_u32 m0, s64, 81920
    s_add_u32 s97, s19, 1376256
    buffer_load_dwordx4 v12, s[48:51], s97 offen lds
    v_mfma_f32_32x32x16_bf16 v[176:191], v[52:55], a[196:199], v[176:191]
    ds_read_b64_tr_b16 v[46:47], v17 offset:17408
    buffer_load_dwordx4 v13, s[48:51], s97 offen offset:1024 lds
    s_waitcnt vmcnt(14) lgkmcnt(4)
    v_mfma_f32_32x32x16_bf16 v[128:143], v[32:35], a[200:203], v[128:143]
    ds_read_b64_tr_b16 v[48:49], v16 offset:24576
    ds_read_b64_tr_b16 v[50:51], v16 offset:25600
    v_mfma_f32_32x32x16_bf16 v[144:159], v[32:35], a[204:207], v[144:159]
    s_add_u32 s98, s18, 245760
    buffer_load_dwordx4 a[248:251], v8, s[44:47], s98 offen sc1
    v_mfma_f32_32x32x16_bf16 v[160:175], v[36:39], a[200:203], v[160:175]
    ds_read_b64_tr_b16 v[52:53], v17 offset:24576
    ds_read_b64_tr_b16 v[54:55], v17 offset:25600
    v_mfma_f32_32x32x16_bf16 v[176:191], v[36:39], a[204:207], v[176:191]
    buffer_load_dwordx4 a[252:255], v9, s[44:47], s98 offen sc1
    s_waitcnt vmcnt(14) lgkmcnt(4)
    v_mfma_f32_32x32x16_bf16 v[128:143], v[40:43], a[208:211], v[128:143]
    ds_read_b64_tr_b16 v[32:33], v18 offset:32768
    ds_read_b64_tr_b16 v[34:35], v18 offset:33792
    v_mfma_f32_32x32x16_bf16 v[144:159], v[40:43], a[212:215], v[144:159]
    s_add_u32 s98, s18, 262144
    buffer_load_dwordx4 a[0:3], v8, s[44:47], s98 offen sc1
    v_mfma_f32_32x32x16_bf16 v[160:175], v[44:47], a[208:211], v[160:175]
    ds_read_b64_tr_b16 v[36:37], v19 offset:32768
    ds_read_b64_tr_b16 v[38:39], v19 offset:33792
    v_mfma_f32_32x32x16_bf16 v[176:191], v[44:47], a[212:215], v[176:191]
    buffer_load_dwordx4 a[4:7], v9, s[44:47], s98 offen sc1
    s_waitcnt vmcnt(14) lgkmcnt(4)
    v_mfma_f32_32x32x16_bf16 v[128:143], v[48:51], a[216:219], v[128:143]
    ds_read_b64_tr_b16 v[40:41], v18 offset:40960
    ds_read_b64_tr_b16 v[42:43], v18 offset:41984
    v_mfma_f32_32x32x16_bf16 v[144:159], v[48:51], a[220:223], v[144:159]
    s_add_u32 s98, s18, 278528
    buffer_load_dwordx4 a[8:11], v8, s[44:47], s98 offen sc1
    v_mfma_f32_32x32x16_bf16 v[160:175], v[52:55], a[216:219], v[160:175]
    ds_read_b64_tr_b16 v[44:45], v19 offset:40960
    ds_read_b64_tr_b16 v[46:47], v19 offset:41984
    v_mfma_f32_32x32x16_bf16 v[176:191], v[52:55], a[220:223], v[176:191]
    buffer_load_dwordx4 a[12:15], v9, s[44:47], s98 offen sc1
    s_waitcnt vmcnt(14) lgkmcnt(4)
    v_mfma_f32_32x32x16_bf16 v[128:143], v[32:35], a[224:227], v[128:143]
    ds_read_b64_tr_b16 v[48:49], v18 offset:49152
    ds_read_b64_tr_b16 v[50:51], v18 offset:50176
    v_mfma_f32_32x32x16_bf16 v[144:159], v[32:35], a[228:231], v[144:159]
    s_add_u32 s98, s18, 294912
    buffer_load_dwordx4 a[16:19], v8, s[44:47], s98 offen sc1
    v_mfma_f32_32x32x16_bf16 v[160:175], v[36:39], a[224:227], v[160:175]
    ds_read_b64_tr_b16 v[52:53], v19 offset:49152
    ds_read_b64_tr_b16 v[54:55], v19 offset:50176
    v_mfma_f32_32x32x16_bf16 v[176:191], v[36:39], a[228:231], v[176:191]
    buffer_load_dwordx4 a[20:23], v9, s[44:47], s98 offen sc1
    s_waitcnt vmcnt(14) lgkmcnt(4)
    v_mfma_f32_32x32x16_bf16 v[128:143], v[40:43], a[232:235], v[128:143]
    ds_read_b64_tr_b16 v[32:33], v18 offset:57344
    ds_read_b64_tr_b16 v[34:35], v18 offset:58368
    v_mfma_f32_32x32x16_bf16 v[144:159], v[40:43], a[236:239], v[144:159]
    s_add_u32 s98, s18, 311296
    buffer_load_dwordx4 a[24:27], v8, s[44:47], s98 offen sc1
    v_mfma_f32_32x32x16_bf16 v[160:175], v[44:47], a[232:235], v[160:175]
    ds_read_b64_tr_b16 v[36:37], v19 offset:57344
    ds_read_b64_tr_b16 v[38:39], v19 offset:58368
    v_mfma_f32_32x32x16_bf16 v[176:191], v[44:47], a[236:239], v[176:191]
    buffer_load_dwordx4 a[28:31], v9, s[44:47], s98 offen sc1
    s_waitcnt vmcnt(12) lgkmcnt(4)
    v_mfma_f32_32x32x16_bf16 v[128:143], v[48:51], a[240:243], v[128:143]
    ds_read_b64_tr_b16 v[40:41], v20 offset:0
    ds_read_b64_tr_b16 v[42:43], v20 offset:1024
    v_mfma_f32_32x32x16_bf16 v[144:159], v[48:51], a[244:247], v[144:159]
    s_add_u32 s98, s18, 327680
    buffer_load_dwordx4 a[32:35], v8, s[44:47], s98 offen sc1
    v_mfma_f32_32x32x16_bf16 v[160:175], v[52:55], a[240:243], v[160:175]
    ds_read_b64_tr_b16 v[44:45], v21 offset:0
    ds_read_b64_tr_b16 v[46:47], v21 offset:1024
    v_mfma_f32_32x32x16_bf16 v[176:191], v[52:55], a[244:247], v[176:191]
    buffer_load_dwordx4 a[36:39], v9, s[44:47], s98 offen sc1
    s_waitcnt vmcnt(10) lgkmcnt(4)
    v_mfma_f32_32x32x16_bf16 v[128:143], v[32:35], a[248:251], v[128:143]
    ds_read_b64_tr_b16 v[48:49], v20 offset:8192
    ds_read_b64_tr_b16 v[50:51], v20 offset:9216
    v_mfma_f32_32x32x16_bf16 v[144:159], v[32:35], a[252:255], v[144:159]
    s_add_u32 s98, s18, 344064
    buffer_load_dwordx4 a[40:43], v8, s[44:47], s98 offen sc1
    ds_read_b64_tr_b16 v[52:53], v21 offset:8192
    v_mfma_f32_32x32x16_bf16 v[160:175], v[36:39], a[248:251], v[160:175]
    buffer_load_dwordx4 a[44:47], v9, s[44:47], s98 offen sc1
    ds_read_b64_tr_b16 v[54:55], v21 offset:9216
    v_mfma_f32_32x32x16_bf16 v[176:191], v[36:39], a[252:255], v[176:191]
    s_barrier
    s_waitcnt vmcnt(10) lgkmcnt(4)
    v_mfma_f32_32x32x16_bf16 v[128:143], v[40:43], a[0:3], v[128:143]
    ds_read_b64_tr_b16 v[32:33], v20 offset:16384
    v_mfma_f32_32x32x16_bf16 v[144:159], v[40:43], a[4:7], v[144:159]
    ds_read_b64_tr_b16 v[34:35], v20 offset:17408
    v_mfma_f32_32x32x16_bf16 v[160:175], v[44:47], a[0:3], v[160:175]
    ds_read_b64_tr_b16 v[36:37], v21 offset:16384
    v_mfma_f32_32x32x16_bf16 v[176:191], v[44:47], a[4:7], v[176:191]
    ds_read_b64_tr_b16 v[38:39], v21 offset:17408
    s_waitcnt vmcnt(8) lgkmcnt(4)
    v_mfma_f32_32x32x16_bf16 v[128:143], v[48:51], a[8:11], v[128:143]
    ds_read_b64_tr_b16 v[40:41], v20 offset:24576
    v_mfma_f32_32x32x16_bf16 v[144:159], v[48:51], a[12:15], v[144:159]
    ds_read_b64_tr_b16 v[42:43], v20 offset:25600
    v_mfma_f32_32x32x16_bf16 v[160:175], v[52:55], a[8:11], v[160:175]
    ds_read_b64_tr_b16 v[44:45], v21 offset:24576
    v_mfma_f32_32x32x16_bf16 v[176:191], v[52:55], a[12:15], v[176:191]
    ds_read_b64_tr_b16 v[46:47], v21 offset:25600
    s_waitcnt vmcnt(6) lgkmcnt(4)
    v_mfma_f32_32x32x16_bf16 v[128:143], v[32:35], a[16:19], v[128:143]
    ds_read_b64_tr_b16 v[48:49], v18 offset:8192
    v_mfma_f32_32x32x16_bf16 v[144:159], v[32:35], a[20:23], v[144:159]
    ds_read_b64_tr_b16 v[50:51], v18 offset:9216
    v_mfma_f32_32x32x16_bf16 v[160:175], v[36:39], a[16:19], v[160:175]
    ds_read_b64_tr_b16 v[52:53], v19 offset:8192
    v_mfma_f32_32x32x16_bf16 v[176:191], v[36:39], a[20:23], v[176:191]
    ds_read_b64_tr_b16 v[54:55], v19 offset:9216
    s_waitcnt vmcnt(4) lgkmcnt(4)
    v_mfma_f32_32x32x16_bf16 v[128:143], v[40:43], a[24:27], v[128:143]
    ds_read_b64_tr_b16 v[32:33], v18 offset:16384
    v_mfma_f32_32x32x16_bf16 v[144:159], v[40:43], a[28:31], v[144:159]
    ds_read_b64_tr_b16 v[34:35], v18 offset:17408
    v_mfma_f32_32x32x16_bf16 v[160:175], v[44:47], a[24:27], v[160:175]
    ds_read_b64_tr_b16 v[36:37], v19 offset:16384
    v_mfma_f32_32x32x16_bf16 v[176:191], v[44:47], a[28:31], v[176:191]
    ds_read_b64_tr_b16 v[38:39], v19 offset:17408
    s_lshl_b32 m0, s3, 14
    s_lshl_b32 s12, s17, 7
    v_xor_b32 v30, 16, v29
    v_and_b32 v2, 8, v1
    v_cmp_eq_u32 vcc, 0, v2
    s_add_u32 s13, s12, 8192
    s_waitcnt vmcnt(2) lgkmcnt(4)
    v_mfma_f32_32x32x16_bf16 v[128:143], v[48:51], a[32:35], v[128:143]
    s_waitcnt vmcnt(0) lgkmcnt(0)
    v_mfma_f32_32x32x16_bf16 v[128:143], v[32:35], a[40:43], v[128:143]
    v_mfma_f32_32x32x16_bf16 v[144:159], v[48:51], a[36:39], v[144:159]
    v_mfma_f32_32x32x16_bf16 v[144:159], v[32:35], a[44:47], v[144:159]
    v_mfma_f32_32x32x16_bf16 v[160:175], v[52:55], a[32:35], v[160:175]
    s_nop 8
    ds_write_addtid_b32 v128 offset:0
    ds_write_addtid_b32 v129 offset:256
    ds_write_addtid_b32 v130 offset:512
    ds_write_addtid_b32 v131 offset:768
    ds_write_addtid_b32 v132 offset:1024
    ds_write_addtid_b32 v133 offset:1280
    v_mfma_f32_32x32x16_bf16 v[160:175], v[36:39], a[40:43], v[160:175]
    ds_write_addtid_b32 v134 offset:1536
    ds_write_addtid_b32 v135 offset:1792
    ds_write_addtid_b32 v136 offset:2048
    ds_write_addtid_b32 v137 offset:2304
    ds_write_addtid_b32 v138 offset:2560
    ds_write_addtid_b32 v139 offset:2816
    v_mfma_f32_32x32x16_bf16 v[176:191], v[52:55], a[36:39], v[176:191]
    ds_write_addtid_b32 v140 offset:3072
    ds_write_addtid_b32 v141 offset:3328
    ds_write_addtid_b32 v142 offset:3584
    ds_write_addtid_b32 v143 offset:3840
    ds_write_addtid_b32 v144 offset:4096
    ds_write_addtid_b32 v145 offset:4352
    v_mfma_f32_32x32x16_bf16 v[176:191], v[36:39], a[44:47], v[176:191]
    ds_write_addtid_b32 v146 offset:4608
    ds_write_addtid_b32 v147 offset:4864
    ds_write_addtid_b32 v148 offset:5120
    ds_write_addtid_b32 v149 offset:5376
    ds_write_addtid_b32 v150 offset:5632
    ds_write_addtid_b32 v151 offset:5888
    ds_write_addtid_b32 v152 offset:6144
    ds_write_addtid_b32 v153 offset:6400
    ds_write_addtid_b32 v154 offset:6656
    ds_write_addtid_b32 v155 offset:6912
    ds_write_addtid_b32 v156 offset:7168
    ds_write_addtid_b32 v157 offset:7424
    ds_write_addtid_b32 v158 offset:7680
    ds_write_addtid_b32 v159 offset:7936
    ds_write_addtid_b32 v160 offset:8192
    ds_write_addtid_b32 v161 offset:8448
    ds_write_addtid_b32 v162 offset:8704
    ds_write_addtid_b32 v163 offset:8960
    ds_write_addtid_b32 v164 offset:9216
    ds_write_addtid_b32 v165 offset:9472
    ds_write_addtid_b32 v166 offset:9728
    ds_write_addtid_b32 v167 offset:9984
    ds_write_addtid_b32 v168 offset:10240
    ds_write_addtid_b32 v169 offset:10496
    ds_write_addtid_b32 v170 offset:10752
    ds_write_addtid_b32 v171 offset:11008
    ds_write_addtid_b32 v172 offset:11264
    ds_write_addtid_b32 v173 offset:11520
    ds_write_addtid_b32 v174 offset:11776
    ds_write_addtid_b32 v175 offset:12032
    ds_write_addtid_b32 v176 offset:12288
    ds_write_addtid_b32 v177 offset:12544
    ds_write_addtid_b32 v178 offset:12800
    ds_write_addtid_b32 v179 offset:13056
    ds_write_addtid_b32 v180 offset:13312
    ds_write_addtid_b32 v181 offset:13568
    ds_write_addtid_b32 v182 offset:13824
    ds_write_addtid_b32 v183 offset:14080
    ds_write_addtid_b32 v184 offset:14336
    ds_write_addtid_b32 v185 offset:14592
    ds_write_addtid_b32 v186 offset:14848
    ds_write_addtid_b32 v187 offset:15104
    ds_write_addtid_b32 v188 offset:15360
    ds_write_addtid_b32 v189 offset:15616
    ds_write_addtid_b32 v190 offset:15872
    ds_write_addtid_b32 v191 offset:16128
    s_waitcnt lgkmcnt(0)
    s_barrier
    ds_read_b128 v[64:67], v29 offset:0
    ds_read_b128 v[68:71], v30 offset:0
    ds_read_b128 v[80:83], v29 offset:16384
    ds_read_b128 v[84:87], v30 offset:16384
    ds_read_b128 v[96:99], v29 offset:32768
    ds_read_b128 v[100:103], v30 offset:32768
    ds_read_b128 v[112:115], v29 offset:49152
    ds_read_b128 v[116:119], v30 offset:49152
    ds_read_b128 v[72:75], v29 offset:1024
    ds_read_b128 v[76:79], v30 offset:1024
    ds_read_b128 v[88:91], v29 offset:17408
    ds_read_b128 v[92:95], v30 offset:17408
    ds_read_b128 v[104:107], v29 offset:33792
    ds_read_b128 v[108:111], v30 offset:33792
    ds_read_b128 v[120:123], v29 offset:50176
    ds_read_b128 v[124:127], v30 offset:50176
    s_waitcnt lgkmcnt(8)
    v_pk_add_f32 v[64:65], v[64:65], v[80:81]
    v_pk_add_f32 v[66:67], v[66:67], v[82:83]
    v_pk_add_f32 v[68:69], v[68:69], v[84:85]
    v_pk_add_f32 v[70:71], v[70:71], v[86:87]
    v_pk_add_f32 v[96:97], v[96:97], v[112:113]
    v_pk_add_f32 v[98:99], v[98:99], v[114:115]
    v_pk_add_f32 v[100:101], v[100:101], v[116:117]
    v_pk_add_f32 v[102:103], v[102:103], v[118:119]
    v_pk_add_f32 v[64:65], v[64:65], v[96:97]
    v_pk_add_f32 v[66:67], v[66:67], v[98:99]
    v_pk_add_f32 v[68:69], v[68:69], v[100:101]
    v_pk_add_f32 v[70:71], v[70:71], v[102:103]
    v_pk_fma_f32 v[64:65], v[64:65], v[56:57], v[58:59] op_sel_hi:[1,0,0]
    v_pk_fma_f32 v[66:67], v[66:67], v[56:57], v[58:59] op_sel_hi:[1,0,0]
    v_pk_fma_f32 v[68:69], v[68:69], v[56:57], v[58:59] op_sel_hi:[1,0,0]
    v_pk_fma_f32 v[70:71], v[70:71], v[56:57], v[58:59] op_sel_hi:[1,0,0]
    v_cvt_pk_bf16_f32 v40, v64, v65
    v_cvt_pk_bf16_f32 v41, v66, v67
    v_cvt_pk_bf16_f32 v42, v68, v69
    v_cvt_pk_bf16_f32 v43, v70, v71
    v_cndmask_b32 v32, v42, v40, vcc
    v_cndmask_b32 v33, v43, v41, vcc
    v_cndmask_b32 v34, v40, v42, vcc
    v_cndmask_b32 v35, v41, v43, vcc
    buffer_store_dwordx4 v[32:35], v27, s[56:59], s12 offen sc1
    s_waitcnt lgkmcnt(0)
    v_pk_add_f32 v[72:73], v[72:73], v[88:89]
    v_pk_add_f32 v[74:75], v[74:75], v[90:91]
    v_pk_add_f32 v[76:77], v[76:77], v[92:93]
    v_pk_add_f32 v[78:79], v[78:79], v[94:95]
    v_pk_add_f32 v[104:105], v[104:105], v[120:121]
    v_pk_add_f32 v[106:107], v[106:107], v[122:123]
    v_pk_add_f32 v[108:109], v[108:109], v[124:125]
    v_pk_add_f32 v[110:111], v[110:111], v[126:127]
    v_pk_add_f32 v[72:73], v[72:73], v[104:105]
    v_pk_add_f32 v[74:75], v[74:75], v[106:107]
    v_pk_add_f32 v[76:77], v[76:77], v[108:109]
    v_pk_add_f32 v[78:79], v[78:79], v[110:111]
    v_pk_fma_f32 v[72:73], v[72:73], v[22:23], v[22:23] op_sel:[0,0,1] op_sel_hi:[1,0,1]
    v_pk_fma_f32 v[74:75], v[74:75], v[22:23], v[22:23] op_sel:[0,0,1] op_sel_hi:[1,0,1]
    v_pk_fma_f32 v[76:77], v[76:77], v[22:23], v[22:23] op_sel:[0,0,1] op_sel_hi:[1,0,1]
    v_pk_fma_f32 v[78:79], v[78:79], v[22:23], v[22:23] op_sel:[0,0,1] op_sel_hi:[1,0,1]
    v_cvt_pk_bf16_f32 v40, v72, v73
    v_cvt_pk_bf16_f32 v41, v74, v75
    v_cvt_pk_bf16_f32 v42, v76, v77
    v_cvt_pk_bf16_f32 v43, v78, v79
    v_cndmask_b32 v36, v42, v40, vcc
    v_cndmask_b32 v37, v43, v41, vcc
    v_cndmask_b32 v38, v40, v42, vcc
    v_cndmask_b32 v39, v41, v43, vcc
    buffer_store_dwordx4 v[36:39], v27, s[56:59], s13 offen sc1
    s_xor_b32 s12, s2, 255
    s_or_b32 s12, s12, s3
    s_cmp_lg_u32 s12, 0
    s_cbranch_scc1 L_fin
    s_mov_b32 s71, 11723776
    v_mov_b32 v2, s96
    v_mov_b32 v3, 0
    s_mov_b64 exec, 1
    buffer_store_dword v2, v3, s[40:43], s71 offen sc1
    s_mov_b64 exec, -1
L_fin:
L_end:
    s_endpgm

.section .rodata,"a"
.p2align 6
.amdhsa_kernel gated_mix__linear_attn_block__mixer_token_mlp__prompt_kernel
  .amdhsa_next_free_vgpr 512
  .amdhsa_next_free_sgpr 102
  .amdhsa_accum_offset 256
  .amdhsa_group_segment_fixed_size 0
  .amdhsa_kernarg_size 96
  .amdhsa_user_sgpr_count 2
  .amdhsa_user_sgpr_kernarg_segment_ptr 1
  .amdhsa_system_sgpr_workgroup_id_x 1
  .amdhsa_float_denorm_mode_32 3
.end_amdhsa_kernel
```
